```python
import torch

def _softmax(x, axis=-1):
    return torch.softmax(x, dim=axis)
def _gelu(x):
    return torch.nn.functional.gelu(x, approximate="tanh")
def _silu(x):
    return torch.nn.functional.silu(x)
def _sigmoid(x):
    return torch.sigmoid(x)
def _layernorm(x, axis=-1, eps=1e-5):
    m = x.mean(dim=axis, keepdim=True)
    v = x.var(dim=axis, keepdim=True, unbiased=False)
    return (x - m) / torch.sqrt(v + eps)
def _scatter_add(tgt, idx, src, axis=0):
    return tgt.clone().index_add_(axis, idx, src)
def _segment_sum(src, seg, n):
    out = torch.zeros((n,) + src.shape[1:], dtype=src.dtype)
    return out.index_add_(0, seg, src)
def _pad(x, pw):
    flat = tuple(v for pair in reversed(pw) for v in pair)
    return torch.nn.functional.pad(x, flat)

kernel_name = 'gather_scatter__graph_attention_gat__graph'

def setup_inputs():

    _w = (lambda a: (lambda t: t.to(torch.bfloat16) if t.is_floating_point() else t)(torch.as_tensor(a)))
    N, deg, D = 10000, 16, 256
    H = 4
    E = N * deg
    return {
        "x": _w((lambda *s: torch.randn(*s, dtype=torch.bfloat16) * 0.4)(N, D) * 0.1),
        "src": _w((lambda lo, hi, *s: torch.randint(lo, hi, s))(0, N, E).to(torch.int64)),
        "dst": _w((lambda lo, hi, *s: torch.randint(lo, hi, s))(0, N, E).to(torch.int64)),
        "w": _w((lambda *s: torch.randn(*s, dtype=torch.bfloat16) * 1.6)(H, D, D) * (1.0 / D ** 0.5)),
        "a_src": _w((lambda *s: torch.randn(*s, dtype=torch.bfloat16) * 1.6)(H, D) * 0.1),
        "a_dst": _w((lambda *s: torch.randn(*s, dtype=torch.bfloat16) * 1.6)(H, D) * 0.1),
    }

def reference(x, src, dst, w, a_src, a_dst):
    N, D = x.shape
    H = w.shape[0]
    h = torch.einsum('nd,hdf->nhf', x, w)
    hs = h[src]
    hd = h[dst]
    e = torch.einsum('ehf,hf->eh', hs, a_src) + torch.einsum('ehf,hf->eh', hd, a_dst)
    e = torch.where(e > 0, e, 0.2 * e)
    exp_e = torch.exp(e)
    denom = _segment_sum(exp_e, dst, N) + 1e-9
    alpha = exp_e / denom[dst]
    out = _segment_sum(alpha[:, :, None] * hs, dst, N)
    return out.mean(1)
```

```asm
; @launch grid=(250,1,1) block=(512,1,1) lds=152704
.amdgcn_target "amdgcn-amd-amdhsa--gfx950"
.text
.globl gather_scatter__graph_attention_gat__graph_kernel
.p2align 8
.type gather_scatter__graph_attention_gat__graph_kernel,@function
gather_scatter__graph_attention_gat__graph_kernel:
    s_cmp_ge_u32 s2, 250
    s_cbranch_scc1 L_end
    s_load_dwordx16 s[72:87], s[0:1], 0
    s_load_dwordx2 s[88:89], s[0:1], 64
    s_getpc_b64 s[98:99]
L_pc:
    v_lshlrev_b32 v254, 6, v0
    v_min_u32 v254, L_hot_end-L_pc, v254
    global_load_dword v255, v254, s[98:99]
    s_memrealtime s[50:51]
    v_lshrrev_b32 v24, 6, v0
    v_and_b32 v1, 63, v0
    v_readfirstlane_b32 s40, v24
    v_mov_b32 v104, 4294963200
    v_mov_b32 v105, 4294963200
    v_mov_b32 v106, 4294963200
    v_mov_b32 v107, 4294963200
    v_lshlrev_b32 v103, 4, v0
    v_add_u32 v103, 49152, v103
    ds_write_b128 v103, v[104:107]
    ds_write_b128 v103, v[104:107] offset:8192
    v_mov_b32 v108, 0
    v_mov_b32 v109, 0
    v_mov_b32 v110, 0
    v_mov_b32 v111, 0
    v_cmpx_gt_u32 vcc, 64, v0
    ds_write_b128 v103, v[108:111] offset:16384
    s_mov_b64 exec, -1
    s_lshr_b32 s41, s40, 2
    s_and_b32 s42, s40, 3
    s_mov_b32 s96, 0
    v_and_b32 v26, 15, v1
    v_lshrrev_b32 v28, 4, v1
    v_lshlrev_b32 v28, 4, v28
    v_lshl_add_u32 v29, v26, 9, v28
    v_and_b32 v26, 1, v1
    v_cmp_eq_u32 vcc, 1, v26
    v_lshlrev_b32 v24, 3, v0
    v_lshlrev_b32 v25, 2, v0
    s_waitcnt lgkmcnt(0)
    s_cmp_eq_u32 s41, 1
    s_cbranch_scc1 L_iss1_1
    s_mov_b32 s20, s76
    s_and_b32 s21, s77, 0xffff
    s_mov_b32 s22, 640000
    s_mov_b32 s23, 0x20000
    s_mov_b32 s16, s74
    s_and_b32 s17, s75, 0xffff
    s_mov_b32 s18, 640000
    s_mov_b32 s19, 0x20000
    s_mul_i32 s65, s2, 2560
    buffer_load_dwordx2 v[32:33], v24, s[20:23], s65 offen
    buffer_load_dwordx2 v[34:35], v24, s[16:19], s65 offen
    s_cmp_lt_u32 s40, 2
    s_cselect_b64 exec, -1, 0
    buffer_load_dword v36, v25, s[20:23], s65 offen offset:2048
    buffer_load_dword v37, v25, s[16:19], s65 offen offset:2048
    s_mov_b32 s32, s86
    s_and_b32 s33, s87, 0xffff
    s_mov_b32 s34, 256
    s_mov_b32 s35, 0x20000
    s_or_b32 s65, s2, s40
    s_bitset1_b32 s50, 31
    s_bitset1_b32 s51, 31
    v_mov_b32 v38, s50
    v_mov_b32 v39, s51
    s_cmp_eq_u32 s65, 0
    s_cselect_b32 exec_lo, 1, 0
    s_mov_b32 exec_hi, 0
    buffer_store_dwordx2 v[38:39], off, s[32:35], 0 sc1
    s_mov_b64 exec, -1
    s_branch L_issdone_2
L_iss1_1:
    s_sub_u32 s98, s40, 4
    s_mov_b32 s8, s78
    s_and_b32 s9, s79, 0xffff
    s_mov_b32 s10, 524288
    s_mov_b32 s11, 0x20000
    s_sub_u32 s99, s2, 64
    s_cmp_ge_u32 s99, 128
    s_cbranch_scc1 L_not3_3
    s_lshr_b32 s65, s99, 6
    s_lshl_b32 s65, s65, 16
    s_and_b32 s66, s99, 15
    s_lshl_b32 s66, s66, 12
    s_add_u32 s65, s65, s66
    s_bfe_u32 s66, s99, 0x20004
    s_lshl_b32 s66, s66, 7
    s_add_u32 s65, s65, s66
    s_lshl_b32 s66, s98, 5
    s_add_u32 s65, s65, s66
    v_and_b32 v26, 15, v1
    v_lshlrev_b32 v26, 1, v26
    v_lshl_add_u32 v26, v28, 6, v26
    s_add_u32 s66, s65, 0
    buffer_load_ushort v96, v26, s[8:11], s66 offen offset:0
    s_add_u32 s66, s65, 131072
    buffer_load_ushort v92, v26, s[8:11], s66 offen offset:0
    s_add_u32 s66, s65, 262144
    buffer_load_ushort v97, v26, s[8:11], s66 offen offset:0
    s_add_u32 s66, s65, 393216
    buffer_load_ushort v93, v26, s[8:11], s66 offen offset:0
    s_add_u32 s66, s65, 0
    buffer_load_ushort v98, v26, s[8:11], s66 offen offset:512
    s_add_u32 s66, s65, 131072
    buffer_load_ushort v94, v26, s[8:11], s66 offen offset:512
    s_add_u32 s66, s65, 262144
    buffer_load_ushort v99, v26, s[8:11], s66 offen offset:512
    s_add_u32 s66, s65, 393216
    buffer_load_ushort v95, v26, s[8:11], s66 offen offset:512
    s_branch L_issdone_2
L_not3_3:
    s_cmp_lg_u32 s98, 3
    s_cbranch_scc1 L_issdone_2
    s_cmp_ge_u32 s2, 64
    s_cbranch_scc1 L_issdone_2
    s_lshl_b32 s65, s2, 13
    buffer_load_dwordx4 v[32:35], v29, s[8:11], s65 offen offset:0
    buffer_load_dwordx4 v[36:39], v29, s[8:11], s65 offen offset:64
    buffer_load_dwordx4 v[40:43], v29, s[8:11], s65 offen offset:128
    buffer_load_dwordx4 v[44:47], v29, s[8:11], s65 offen offset:192
    buffer_load_dwordx4 v[48:51], v29, s[8:11], s65 offen offset:256
    buffer_load_dwordx4 v[52:55], v29, s[8:11], s65 offen offset:320
    buffer_load_dwordx4 v[56:59], v29, s[8:11], s65 offen offset:384
    buffer_load_dwordx4 v[60:63], v29, s[8:11], s65 offen offset:448
    v_mov_b32 v26, s80
    v_mov_b32 v27, s82
    v_cndmask_b32 v26, v26, v27, vcc
    v_mov_b32 v27, s81
    v_mov_b32 v30, s83
    v_cndmask_b32 v27, v27, v30, vcc
    s_lshr_b32 s66, s2, 4
    s_lshl_b32 s66, s66, 9
    v_add_u32 v28, s66, v28
    v_add_co_u32 v26, vcc, v26, v28
    s_nop 1
    v_addc_co_u32 v27, vcc, 0, v27, vcc
    global_load_dwordx4 v[64:67], v[26:27], off offset:0
    global_load_dwordx4 v[68:71], v[26:27], off offset:64
    global_load_dwordx4 v[72:75], v[26:27], off offset:128
    global_load_dwordx4 v[76:79], v[26:27], off offset:192
    global_load_dwordx4 v[80:83], v[26:27], off offset:256
    global_load_dwordx4 v[84:87], v[26:27], off offset:320
    global_load_dwordx4 v[88:91], v[26:27], off offset:384
    global_load_dwordx4 v[92:95], v[26:27], off offset:448
L_issdone_2:
    s_mov_b32 s32, s86
    s_and_b32 s33, s87, 0xffff
    s_mov_b32 s34, 256
    s_mov_b32 s35, 0x20000
    s_barrier
    s_mov_b32 s12, s88
    s_and_b32 s13, s89, 0xffff
    s_mov_b32 s14, 6291456
    s_mov_b32 s15, 0x20000
    s_sub_u32 s4, s72, 4096
    s_subb_u32 s5, s73, 0
    s_and_b32 s5, s5, 0xffff
    s_mov_b32 s6, 5124096
    s_mov_b32 s7, 0x20000
    s_mov_b32 s8, s78
    s_and_b32 s9, s79, 0xffff
    s_mov_b32 s10, 524288
    s_mov_b32 s11, 0x20000
    s_mov_b32 s20, s76
    s_and_b32 s21, s77, 0xffff
    s_mov_b32 s22, 640000
    s_mov_b32 s23, 0x20000
    s_mov_b32 s16, s74
    s_and_b32 s17, s75, 0xffff
    s_mov_b32 s18, 640000
    s_mov_b32 s19, 0x20000
    s_mov_b32 s36, s84
    s_and_b32 s37, s85, 0xffff
    s_mov_b32 s38, 5120000
    s_mov_b32 s39, 0x20000
    v_and_b32 v24, 15, v1
    v_lshrrev_b32 v25, 4, v1
    s_lshr_b32 s43, s42, 1
    s_mul_i32 s56, s40, 12288
    s_and_b32 s65, s42, 1
    s_lshl_b32 s66, s41, 1
    s_add_u32 s48, s65, s66
    v_lshrrev_b32 v26, 3, v24
    v_and_b32 v27, 1, v25
    v_lshl_or_b32 v26, v27, 1, v26
    v_lshrrev_b32 v27, 2, v24
    v_lshlrev_b32 v27, 7, v27
    v_lshl_add_u32 v27, v25, 10, v27
    v_bfe_u32 v28, v24, 1, 1
    v_lshl_add_u32 v27, v28, 4, v27
    v_and_b32 v28, 1, v24
    v_lshl_add_u32 v27, v28, 3, v27
    v_add_u32 v27, s56, v27
    v_xor_b32 v28, 0, v26
    v_lshl_add_u32 v2, v28, 5, v27
    v_xor_b32 v28, 1, v26
    v_lshl_add_u32 v3, v28, 5, v27
    v_xor_b32 v28, 2, v26
    v_lshl_add_u32 v4, v28, 5, v27
    v_xor_b32 v28, 3, v26
    v_lshl_add_u32 v5, v28, 5, v27
    v_lshlrev_b32 v23, 4, v1
    v_add_u32 v6, 98304, v23
    v_mov_b32 v7, 147456
    v_lshrrev_b32 v26, 3, v1
    v_lshl_add_u32 v8, v26, 4, v7
    v_and_b32 v27, 2, v26
    v_and_b32 v28, 7, v1
    v_xor_b32 v28, v28, v27
    v_lshlrev_b32 v9, 4, v28
    v_xor_b32 v10, 64, v9
    s_mov_b32 s97, 0xfffffe00
    s_lshl_b32 s65, s48, 7
    s_add_u32 s52, s65, 4096
    s_add_u32 s53, s65, 3072
    s_add_u32 s54, s65, 2048
    s_add_u32 s55, s65, 1024
    s_mov_b32 s95, 4294959104
    s_lshl_b32 s3, s40, 16
    s_add_u32 s3, s3, 4718592
    s_lshl_b32 s65, s41, 5
    s_add_u32 s28, s65, 140368
    s_xor_b32 s65, s65, 32
    s_add_u32 s29, s65, 140368
    v_mov_b32 v104, 0
    v_mov_b32 v105, 0
    v_mov_b32 v106, 0
    v_mov_b32 v107, 0
    v_lshlrev_b32 v103, 4, v0
    v_add_u32 v103, 98304, v103
    ds_write_b128 v103, v[104:107] offset:0
    ds_write_b128 v103, v[104:107] offset:8192
    ds_write_b128 v103, v[104:107] offset:16384
    ds_write_b128 v103, v[104:107] offset:24576
    ds_write_b128 v103, v[104:107] offset:32768
    v_lshlrev_b32 v103, 4, v0
    v_add_u32 v103, 140288, v103
    v_cmpx_gt_u32 vcc, 4, v0
    ds_write_b128 v103, v[104:107]
    s_mov_b64 exec, -1
    v_lshlrev_b32 v103, 3, v0
    v_add_u32 v103, 140360, v103
    v_cmpx_gt_u32 vcc, 10, v0
    ds_write_b64 v103, v[104:105]
    s_mov_b64 exec, -1
    v_mov_b32 v104, 0x40000000
    v_mov_b32 v105, 0x40000000
    v_mov_b32 v106, 0x40000000
    v_mov_b32 v107, 0x40000000
    v_lshlrev_b32 v103, 4, v0
    v_add_u32 v103, 147456, v103
    v_cmpx_gt_u32 vcc, 328, v0
    ds_write_b128 v103, v[104:107] offset:0
    s_mov_b64 exec, -1
    s_cmp_lg_u32 s40, 0
    s_cbranch_scc1 L_nop0_4
    buffer_load_dwordx2 v[38:39], off, s[32:35], 0 sc1
L_nop0_4:
    s_cmp_eq_u32 s41, 1
    s_cbranch_scc1 L_set1
    s_waitcnt vmcnt(1)
    s_cmp_eq_u32 s40, 0
    s_cbranch_scc1 L_w0only_5
    s_waitcnt vmcnt(0)
L_w0only_5:
    s_mov_b32 s92, -40
    s_mov_b32 s93, 65536
    s_mov_b32 s94, 49152
    v_mov_b32 v30, 1
    v_mul_u32_u24 v40, 0xcccd, v32
    v_lshrrev_b32 v40, 21, v40
    v_mad_i32_i24 v41, v40, s92, v32
    v_lshlrev_b32 v42, 18, v34
    v_lshl_or_b32 v41, v41, 12, v42
    v_lshl_add_u32 v43, v40, 2, s93
    v_lshl_add_u32 v42, v40, 6, s94
    ds_add_rtn_u32 v43, v43, v30
    v_mul_u32_u24 v44, 0xcccd, v33
    v_lshrrev_b32 v44, 21, v44
    v_mad_i32_i24 v45, v44, s92, v33
    v_lshlrev_b32 v46, 18, v35
    v_lshl_or_b32 v45, v45, 12, v46
    v_lshl_add_u32 v47, v44, 2, s93
    v_lshl_add_u32 v46, v44, 6, s94
    ds_add_rtn_u32 v47, v47, v30
    s_cmp_lt_u32 s40, 2
    s_cselect_b64 s[70:71], -1, 0
    s_mov_b64 exec, s[70:71]
    v_mul_u32_u24 v48, 0xcccd, v36
    v_lshrrev_b32 v48, 21, v48
    v_mad_i32_i24 v49, v48, s92, v36
    v_lshlrev_b32 v50, 18, v37
    v_lshl_or_b32 v49, v49, 12, v50
    v_lshl_add_u32 v51, v48, 2, s93
    v_lshl_add_u32 v50, v48, 6, s94
    ds_add_rtn_u32 v51, v51, v30
    s_mov_b64 exec, -1
    s_waitcnt lgkmcnt(0)
    v_cmpx_gt_u32 vcc, 16, v43
    v_lshl_add_u32 v42, v43, 2, v42
    ds_write_b32 v42, v41
    s_mov_b64 exec, -1
    v_cmpx_gt_u32 vcc, 16, v47
    v_lshl_add_u32 v46, v47, 2, v46
    ds_write_b32 v46, v45
    s_mov_b64 exec, -1
    s_mov_b64 exec, s[70:71]
    v_cmpx_gt_u32 vcc, 16, v51
    v_lshl_add_u32 v50, v51, 2, v50
    ds_write_b32 v50, v49
    s_mov_b64 exec, -1
    s_cmp_lg_u32 s40, 0
    s_cbranch_scc1 L_nop1_6
    s_waitcnt vmcnt(0)
    v_readfirstlane_b32 s65, v38
    v_readfirstlane_b32 s66, v39
    s_nop 1
    s_and_b32 s65, s65, s66
    s_bitcmp1_b32 s65, 31
    s_cbranch_scc0 L_nretry_7
L_nok_8:
    v_mov_b32 v24, 140352
    ds_write_b64 v24, v[38:39]
L_nop1_6:
    s_waitcnt lgkmcnt(0)
    s_barrier
    v_mov_b32 v24, 140352
    ds_read_b64 v[26:27], v24
    s_waitcnt lgkmcnt(0)
    v_readfirstlane_b32 s65, v26
    v_readfirstlane_b32 s66, v27
    s_nop 1
    s_and_b32 s44, s65, 0xfff
    s_bfe_u32 s45, s65, 0xc000c
    s_bfe_u32 s46, s65, 0x70018
    s_lshl_b32 s65, s66, 7
    s_or_b32 s46, s46, s65
    s_bfe_u32 s47, s66, 0xc0005
    s_mul_i32 s65, s44, 5
    s_add_u32 s45, s45, s65
    s_add_u32 s45, s45, 291
    s_and_b32 s45, s45, 0xfff
    s_mul_i32 s65, s44, 9
    s_add_u32 s46, s46, s65
    s_add_u32 s46, s46, 1110
    s_and_b32 s46, s46, 0xfff
    s_mul_i32 s65, s44, 13
    s_add_u32 s47, s47, s65
    s_add_u32 s47, s47, 1929
    s_and_b32 s47, s47, 0xfff
    v_cmp_gt_u32 vcc, 32, v1
    s_mov_b64 s[70:71], vcc
    s_mov_b32 s100, 0
    s_mov_b32 s101, 63
    v_mov_b32 v26, s40
    v_mov_b32 v27, s40
    v_cndmask_b32 v26, v26, v27, s[70:71]
    v_and_b32 v104, s101, v1
    v_add_u32 v104, s100, v104
    v_lshlrev_b32 v105, 2, v26
    v_add_u32 v105, 140288, v105
    v_lshl_add_u32 v28, v26, 9, v7
    v_lshl_add_u32 v106, v104, 2, v28
    v_lshlrev_b32 v28, 12, v26
    v_lshrrev_b32 v27, 5, v104
    v_lshl_add_u32 v28, v27, 10, v28
    v_and_b32 v27, 3, v104
    v_lshl_add_u32 v28, v27, 8, v28
    v_bfe_u32 v27, v104, 2, 3
    v_lshl_add_u32 v28, v27, 1, v28
    v_add_u32 v107, 98304, v28
    s_add_u32 s65, s40, 8
    s_lshl_b32 s66, s40, 1
    s_sub_u32 s66, s66, 4
    s_add_u32 s67, s66, 1
    s_cmp_lt_u32 s40, 2
    s_cselect_b32 s92, s65, s66
    s_cselect_b32 s93, s65, s67
    s_cselect_b32 s100, 0, 64
    s_cselect_b32 s101, 63, 31
    s_cmp_eq_u32 s40, 7
    s_cselect_b32 s92, 0, s92
    s_cselect_b32 s93, 0, s93
    s_cselect_b32 s100, 0x200, s100
    v_mov_b32 v26, s93
    v_mov_b32 v27, s92
    v_cndmask_b32 v26, v26, v27, s[70:71]
    v_and_b32 v108, s101, v1
    v_add_u32 v108, s100, v108
    v_lshlrev_b32 v109, 2, v26
    v_add_u32 v109, 140288, v109
    v_lshl_add_u32 v28, v26, 9, v7
    v_lshl_add_u32 v110, v108, 2, v28
    v_lshlrev_b32 v28, 12, v26
    v_lshrrev_b32 v27, 5, v108
    v_lshl_add_u32 v28, v27, 10, v28
    v_and_b32 v27, 3, v108
    v_lshl_add_u32 v28, v27, 8, v28
    v_bfe_u32 v27, v108, 2, 3
    v_lshl_add_u32 v28, v27, 1, v28
    v_add_u32 v111, 98304, v28
    s_barrier
    s_branch L_mid
L_set1:
    s_cmp_lg_u32 s98, 3
    s_cbranch_scc1 L_nou2_9
    s_cmp_ge_u32 s2, 64
    s_cbranch_scc1 L_nou2_9
    s_waitcnt vmcnt(0)
    v_mfma_f32_16x16x32_bf16 v[96:99], v[32:35], v[64:67], 0
    v_mfma_f32_16x16x32_bf16 v[96:99], v[36:39], v[68:71], v[96:99]
    v_mfma_f32_16x16x32_bf16 v[96:99], v[40:43], v[72:75], v[96:99]
    v_mfma_f32_16x16x32_bf16 v[96:99], v[44:47], v[76:79], v[96:99]
    v_mfma_f32_16x16x32_bf16 v[96:99], v[48:51], v[80:83], v[96:99]
    v_mfma_f32_16x16x32_bf16 v[96:99], v[52:55], v[84:87], v[96:99]
    v_mfma_f32_16x16x32_bf16 v[96:99], v[56:59], v[88:91], v[96:99]
    v_mfma_f32_16x16x32_bf16 v[96:99], v[60:63], v[92:95], v[96:99]
    s_nop 7
    v_mul_f32 v96, 0x3fb8aa3b, v96
    v_mul_f32 v97, 0x3fb8aa3b, v97
    v_mul_f32 v98, 0x3fb8aa3b, v98
    v_mul_f32 v99, 0x3fb8aa3b, v99
    v_add_u32 v96, 0x800, v96
    v_add_u32 v97, 0x800, v97
    v_add_u32 v98, 0x800, v98
    v_add_u32 v99, 0x800, v99
L_nou2_9:
    s_sub_u32 s99, s2, 64
    s_cmp_ge_u32 s99, 128
    s_cbranch_scc1 L_not3b_10
    s_lshl_b32 s65, s99, 12
    s_lshl_b32 s66, s98, 10
    s_add_u32 s65, s65, s66
    s_add_u32 s65, s65, 4718592
    s_waitcnt vmcnt(0)
    v_lshl_or_b32 v96, v92, 16, v96
    v_lshl_or_b32 v97, v93, 16, v97
    v_lshl_or_b32 v98, v94, 16, v98
    v_lshl_or_b32 v99, v95, 16, v99
    buffer_store_dwordx4 v[96:99], v23, s[12:15], s65 offen sc1
    s_waitcnt vmcnt(0)
L_not3b_10:
    s_waitcnt lgkmcnt(0)
    s_barrier
    v_mov_b32 v24, 140352
    ds_read_b64 v[26:27], v24
    s_waitcnt lgkmcnt(0)
    v_readfirstlane_b32 s65, v26
    v_readfirstlane_b32 s66, v27
    s_nop 1
    s_and_b32 s44, s65, 0xfff
    s_bfe_u32 s45, s65, 0xc000c
    s_bfe_u32 s46, s65, 0x70018
    s_lshl_b32 s65, s66, 7
    s_or_b32 s46, s46, s65
    s_bfe_u32 s47, s66, 0xc0005
    s_mul_i32 s65, s44, 5
    s_add_u32 s45, s45, s65
    s_add_u32 s45, s45, 291
    s_and_b32 s45, s45, 0xfff
    s_mul_i32 s65, s44, 9
    s_add_u32 s46, s46, s65
    s_add_u32 s46, s46, 1110
    s_and_b32 s46, s46, 0xfff
    s_mul_i32 s65, s44, 13
    s_add_u32 s47, s47, s65
    s_add_u32 s47, s47, 1929
    s_and_b32 s47, s47, 0xfff
    s_mov_b32 s92, 0xfffff000
    s_cmp_lg_u32 s98, 3
    s_cbranch_scc1 L_nou3_11
    s_cmp_ge_u32 s2, 64
    s_cbranch_scc1 L_nou3_11
    v_and_b32 v96, s92, v96
    v_and_b32 v97, s92, v97
    v_and_b32 v98, s92, v98
    v_and_b32 v99, s92, v99
    v_or_b32 v96, s44, v96
    v_or_b32 v97, s45, v97
    v_or_b32 v98, s46, v98
    v_or_b32 v99, s47, v99
    v_and_b32 v24, 15, v1
    v_lshrrev_b32 v25, 4, v1
    v_lshl_add_u32 v25, v24, 2, v25
    v_lshlrev_b32 v25, 4, v25
    s_lshl_b32 s65, s2, 7
    s_add_u32 s65, s65, 4194304
    v_cmpx_gt_u32 vcc, 2, v24
    buffer_store_dwordx4 v[96:99], v25, s[12:15], s65 offen sc1
    s_mov_b64 exec, -1
L_nou3_11:
    v_subrev_u32 v29, 256, v0
    v_lshlrev_b32 v24, 4, v29
    v_add_u32 v24, 49152, v24
    v_lshrrev_b32 v25, 2, v29
    v_lshlrev_b32 v26, 2, v25
    v_add_u32 v26, 65536, v26
    ds_read_b128 v[76:79], v24 offset:0
    ds_read_b32 v92, v26 offset:0
    ds_read_b128 v[80:83], v24 offset:4096
    ds_read_b32 v93, v26 offset:256
    ds_read_b128 v[84:87], v24 offset:8192
    ds_read_b32 v94, v26 offset:512
    ds_read_b128 v[88:91], v24 offset:12288
    ds_read_b32 v95, v26 offset:768
    v_mul_u32_u24 v25, 16000, v25
    v_and_b32 v27, 3, v29
    v_lshl_add_u32 v25, v27, 4, v25
    v_cmp_eq_u32 s[70:71], 3, v27
    v_mov_b32 v28, 0xffffe000
    s_lshl_b32 s93, s2, 6
    s_waitcnt lgkmcnt(0)
    v_cmp_lt_u32 vcc, 16, v92
    s_and_b64 vcc, vcc, s[70:71]
    v_or_b32 v76, s44, v76
    v_or_b32 v77, s45, v77
    v_or_b32 v78, s46, v78
    v_cndmask_b32 v79, v79, v28, vcc
    v_or_b32 v79, s47, v79
    buffer_store_dwordx4 v[76:79], v25, s[12:15], s93 offen sc1
    s_add_u32 s93, s93, 1024000
    v_cmp_lt_u32 vcc, 16, v93
    s_and_b64 vcc, vcc, s[70:71]
    v_or_b32 v80, s44, v80
    v_or_b32 v81, s45, v81
    v_or_b32 v82, s46, v82
    v_cndmask_b32 v83, v83, v28, vcc
    v_or_b32 v83, s47, v83
    buffer_store_dwordx4 v[80:83], v25, s[12:15], s93 offen sc1
    s_add_u32 s93, s93, 1024000
    v_cmp_lt_u32 vcc, 16, v94
    s_and_b64 vcc, vcc, s[70:71]
    v_or_b32 v84, s44, v84
    v_or_b32 v85, s45, v85
    v_or_b32 v86, s46, v86
    v_cndmask_b32 v87, v87, v28, vcc
    v_or_b32 v87, s47, v87
    buffer_store_dwordx4 v[84:87], v25, s[12:15], s93 offen sc1
    s_add_u32 s93, s93, 1024000
    v_cmp_lt_u32 vcc, 16, v95
    s_and_b64 vcc, vcc, s[70:71]
    v_or_b32 v88, s44, v88
    v_or_b32 v89, s45, v89
    v_or_b32 v90, s46, v90
    v_cndmask_b32 v91, v91, v28, vcc
    v_or_b32 v91, s47, v91
    v_cmpx_gt_u32 vcc, 232, v29
    buffer_store_dwordx4 v[88:91], v25, s[12:15], s93 offen sc1
    s_mov_b64 exec, -1
    v_cmp_gt_u32 vcc, 32, v1
    s_mov_b64 s[70:71], vcc
    s_mov_b32 s100, 0
    s_mov_b32 s101, 63
    v_mov_b32 v26, s40
    v_mov_b32 v27, s40
    v_cndmask_b32 v26, v26, v27, s[70:71]
    v_and_b32 v104, s101, v1
    v_add_u32 v104, s100, v104
    v_lshlrev_b32 v105, 2, v26
    v_add_u32 v105, 140288, v105
    v_lshl_add_u32 v28, v26, 9, v7
    v_lshl_add_u32 v106, v104, 2, v28
    v_lshlrev_b32 v28, 12, v26
    v_lshrrev_b32 v27, 5, v104
    v_lshl_add_u32 v28, v27, 10, v28
    v_and_b32 v27, 3, v104
    v_lshl_add_u32 v28, v27, 8, v28
    v_bfe_u32 v27, v104, 2, 3
    v_lshl_add_u32 v28, v27, 1, v28
    v_add_u32 v107, 98304, v28
    s_add_u32 s65, s40, 8
    s_lshl_b32 s66, s40, 1
    s_sub_u32 s66, s66, 4
    s_add_u32 s67, s66, 1
    s_cmp_lt_u32 s40, 2
    s_cselect_b32 s92, s65, s66
    s_cselect_b32 s93, s65, s67
    s_cselect_b32 s100, 0, 64
    s_cselect_b32 s101, 63, 31
    s_cmp_eq_u32 s40, 7
    s_cselect_b32 s92, 0, s92
    s_cselect_b32 s93, 0, s93
    s_cselect_b32 s100, 0x200, s100
    v_mov_b32 v26, s93
    v_mov_b32 v27, s92
    v_cndmask_b32 v26, v26, v27, s[70:71]
    v_and_b32 v108, s101, v1
    v_add_u32 v108, s100, v108
    v_lshlrev_b32 v109, 2, v26
    v_add_u32 v109, 140288, v109
    v_lshl_add_u32 v28, v26, 9, v7
    v_lshl_add_u32 v110, v108, 2, v28
    v_lshlrev_b32 v28, 12, v26
    v_lshrrev_b32 v27, 5, v108
    v_lshl_add_u32 v28, v27, 10, v28
    v_and_b32 v27, 3, v108
    v_lshl_add_u32 v28, v27, 8, v28
    v_bfe_u32 v27, v108, 2, 3
    v_lshl_add_u32 v28, v27, 1, v28
    v_add_u32 v111, 98304, v28
    s_waitcnt vmcnt(0)
    s_barrier
L_mid:
    v_and_b32 v24, 255, v0
    v_lshrrev_b32 v25, 8, v0
    v_lshlrev_b32 v28, 6, v24
    v_lshl_add_u32 v28, v25, 4, v28
    s_mul_i32 s94, s2, 16000
    v_cmp_gt_u32 vcc, 250, v24
    s_mov_b64 s[70:71], vcc
    v_mov_b32 v72, 4294963200
    v_mov_b32 v73, 4294963200
    v_mov_b32 v74, 4294963200
    v_mov_b32 v75, 4294963200
    v_mov_b32 v76, 4294963200
    v_mov_b32 v77, 4294963200
    v_mov_b32 v78, 4294963200
    v_mov_b32 v79, 4294963200
    v_lshlrev_b32 v29, 4, v0
    s_mov_b32 s92, 4194304
    s_mov_b64 exec, s[70:71]
    buffer_load_dwordx4 v[72:75], v28, s[12:15], s94 offen sc1
    buffer_load_dwordx4 v[76:79], v28, s[12:15], s94 offen offset:32 sc1
    s_mov_b64 exec, -1
    buffer_load_dwordx4 v[84:87], v29, s[12:15], s92 offen sc1
    s_barrier
    s_cmp_eq_u32 s41, 0
    s_cbranch_scc1 L_nox1_12
    s_cmp_eq_u32 s40, 7
    s_cbranch_scc1 L_nox_13
    s_sub_u32 s4, s72, 4096
    s_subb_u32 s5, s73, 0
    s_and_b32 s5, s5, 0xffff
    s_mov_b32 s6, 5124096
    s_mov_b32 s7, 0x20000
    s_mul_i32 s65, s2, 40
    s_and_b32 s66, s40, 3
    s_lshl_b32 s66, s66, 4
    s_add_u32 s65, s65, s66
    s_lshl_b32 s65, s65, 9
    s_add_u32 s65, s65, 4096
    v_and_b32 v24, 15, v1
    v_lshlrev_b32 v24, 9, v24
    v_lshrrev_b32 v25, 4, v1
    v_lshl_add_u32 v24, v25, 4, v24
    buffer_load_dwordx4 v[40:43], v24, s[4:7], s65 offen offset:0
    buffer_load_dwordx4 v[44:47], v24, s[4:7], s65 offen offset:64
    buffer_load_dwordx4 v[48:51], v24, s[4:7], s65 offen offset:128
    buffer_load_dwordx4 v[52:55], v24, s[4:7], s65 offen offset:192
    buffer_load_dwordx4 v[56:59], v24, s[4:7], s65 offen offset:256
    buffer_load_dwordx4 v[60:63], v24, s[4:7], s65 offen offset:320
    buffer_load_dwordx4 v[64:67], v24, s[4:7], s65 offen offset:384
    buffer_load_dwordx4 v[68:71], v24, s[4:7], s65 offen offset:448
L_nox_13:
L_nox1_12:
    buffer_load_dword v255, off, s[12:15], 0 sc1
    s_sub_u32 s98, s40, 4
    s_cmp_le_u32 s98, 2
    s_cbranch_scc1 L_w46_14
    s_waitcnt vmcnt(1)
L_w46e_15:
    v_xor_b32 v24, s44, v84
    v_xor_b32 v25, s45, v85
    v_xor_b32 v26, s46, v86
    v_or3_b32 v24, v24, v25, v26
    v_xor_b32 v25, s47, v87
    v_or_b32 v24, v24, v25
    v_and_b32 v24, 0xfff, v24
    v_cmp_ne_u32 vcc, 0, v24
    s_cbranch_vccnz L_u_retry_16
L_u_ok_17:
    s_mov_b32 s92, 0xfffff000
    v_and_b32 v84, s92, v84
    v_and_b32 v85, s92, v85
    v_and_b32 v86, s92, v86
    v_and_b32 v87, s92, v87
    v_bfe_u32 v24, v0, 2, 1
    v_lshrrev_b32 v25, 7, v0
    v_cvt_pk_bf16_f32 v84, v84, v85
    v_cvt_pk_bf16_f32 v85, v86, v87
    v_lshl_add_u32 v24, v24, 2, v25
    v_mul_u32_u24 v24, 528, v24
    v_bfe_u32 v25, v0, 3, 4
    v_lshl_add_u32 v24, v25, 5, v24
    v_and_b32 v25, 3, v0
    v_lshl_add_u32 v24, v25, 3, v24
    v_add_u32 v24, 141312, v24
    ds_write_b64 v24, v[84:85]
    s_waitcnt lgkmcnt(0)
    s_barrier
    s_mov_b64 exec, s[70:71]
    v_xor_b32 v24, s44, v72
    v_xor_b32 v25, s45, v73
    v_xor_b32 v26, s46, v74
    v_or3_b32 v24, v24, v25, v26
    v_xor_b32 v25, s47, v75
    v_or_b32 v24, v24, v25
    v_xor_b32 v25, s44, v76
    v_xor_b32 v26, s45, v77
    v_or3_b32 v24, v24, v25, v26
    v_xor_b32 v25, s46, v78
    v_xor_b32 v26, s47, v79
    v_or3_b32 v24, v24, v25, v26
    v_and_b32 v24, 0xfff, v24
    v_cmp_ne_u32 vcc, 0, v24
    s_cbranch_vccnz L_e_retry_18
L_e_ok_19:
    s_mov_b32 s92, 0xfffc0000
    s_mov_b32 s93, 140288
    s_movk_i32 s99, 0x1e00
    v_mov_b32 v30, 1
    v_cmpx_gt_u32 vcc, s92, v72
    v_lshrrev_b32 v24, 12, v72
    v_and_or_b32 v24, v24, 60, s93
    ds_add_rtn_u32 v80, v24, v30
    v_cmpx_gt_u32 vcc, s92, v73
    v_lshrrev_b32 v24, 12, v73
    v_and_or_b32 v24, v24, 60, s93
    ds_add_rtn_u32 v81, v24, v30
    v_cmpx_gt_u32 vcc, s92, v74
    v_lshrrev_b32 v24, 12, v74
    v_and_or_b32 v24, v24, 60, s93
    ds_add_rtn_u32 v82, v24, v30
    v_cmpx_gt_u32 vcc, s92, v75
    v_lshrrev_b32 v24, 12, v75
    v_and_or_b32 v24, v24, 60, s93
    ds_add_rtn_u32 v83, v24, v30
    s_mov_b64 exec, s[70:71]
    s_waitcnt lgkmcnt(0)
    v_cmpx_gt_u32 vcc, s92, v72
    v_lshrrev_b32 v24, 5, v72
    v_and_or_b32 v24, v24, s99, v7
    v_lshl_add_u32 v24, v80, 2, v24
    v_lshrrev_b32 v25, 9, v72
    ds_write_b32 v24, v25
    v_cmpx_gt_u32 vcc, s92, v73
    v_lshrrev_b32 v24, 5, v73
    v_and_or_b32 v24, v24, s99, v7
    v_lshl_add_u32 v24, v81, 2, v24
    v_lshrrev_b32 v25, 9, v73
    ds_write_b32 v24, v25
    v_cmpx_gt_u32 vcc, s92, v74
    v_lshrrev_b32 v24, 5, v74
    v_and_or_b32 v24, v24, s99, v7
    v_lshl_add_u32 v24, v82, 2, v24
    v_lshrrev_b32 v25, 9, v74
    ds_write_b32 v24, v25
    v_cmpx_gt_u32 vcc, s92, v75
    v_lshrrev_b32 v24, 5, v75
    v_and_or_b32 v24, v24, s99, v7
    v_lshl_add_u32 v24, v83, 2, v24
    v_lshrrev_b32 v25, 9, v75
    ds_write_b32 v24, v25
    s_mov_b64 exec, s[70:71]
    v_cmp_gt_u32 vcc, s92, v76
    s_cbranch_vccnz L_rare_20
L_rareb_21:
    s_mov_b64 exec, -1
    s_waitcnt lgkmcnt(0)
    s_barrier
    s_sub_u32 s98, s40, 4
    s_cmp_gt_u32 s98, 2
    s_cbranch_scc1 L_nos_22
    s_mov_b32 s92, 0xfffff000
    v_and_b32 v24, 7, v1
    v_mul_u32_u24 v24, 528, v24
    v_lshrrev_b32 v25, 4, v1
    v_lshl_add_u32 v24, v25, 4, v24
    v_add_u32 v24, 141312, v24
    ds_read_b128 v[208:211], v24 offset:0
    ds_read_b128 v[212:215], v24 offset:64
    ds_read_b128 v[216:219], v24 offset:128
    ds_read_b128 v[220:223], v24 offset:192
    ds_read_b128 v[224:227], v24 offset:256
    ds_read_b128 v[228:231], v24 offset:320
    ds_read_b128 v[232:235], v24 offset:384
    ds_read_b128 v[236:239], v24 offset:448
    v_and_b32 v24, 15, v1
    s_lshl_b32 s65, s98, 4
    v_add_u32 v24, s65, v24
    v_cmp_gt_u32 s[68:69], 40, v24
    v_lshlrev_b32 v26, 4, v24
    s_mul_i32 s66, s2, 640
    s_add_u32 s66, s66, 4259840
    v_add_u32 v27, 139264, v26
    s_waitcnt vmcnt(1) lgkmcnt(0)
    v_mfma_f32_16x16x32_bf16 v[88:91], v[208:211], v[40:43], 0
    v_mfma_f32_16x16x32_bf16 v[88:91], v[212:215], v[44:47], v[88:91]
    v_mfma_f32_16x16x32_bf16 v[88:91], v[216:219], v[48:51], v[88:91]
    v_mfma_f32_16x16x32_bf16 v[88:91], v[220:223], v[52:55], v[88:91]
    v_mfma_f32_16x16x32_bf16 v[88:91], v[224:227], v[56:59], v[88:91]
    v_mfma_f32_16x16x32_bf16 v[88:91], v[228:231], v[60:63], v[88:91]
    v_mfma_f32_16x16x32_bf16 v[88:91], v[232:235], v[64:67], v[88:91]
    v_mfma_f32_16x16x32_bf16 v[88:91], v[236:239], v[68:71], v[88:91]
    v_cmp_eq_u32 vcc, 0, v25
    s_and_b64 s[66:67], vcc, s[68:69]
    v_cmp_eq_u32 vcc, 1, v25
    s_and_b64 vcc, vcc, s[68:69]
    s_nop 3
    v_add_u32 v92, 0x800, v88
    v_add_u32 v93, 0x800, v89
    v_add_u32 v94, 0x800, v90
    v_add_u32 v95, 0x800, v91
    v_and_b32 v92, s92, v92
    v_and_b32 v93, s92, v93
    v_and_b32 v94, s92, v94
    v_and_b32 v95, s92, v95
    v_or_b32 v92, s44, v92
    v_or_b32 v93, s45, v93
    v_or_b32 v94, s46, v94
    v_or_b32 v95, s47, v95
    s_mov_b64 exec, vcc
    ds_write_b128 v27, v[88:91]
    s_mov_b64 exec, s[66:67]
    s_mul_i32 s66, s2, 640
    s_add_u32 s66, s66, 4259840
    buffer_store_dwordx4 v[92:95], v26, s[12:15], s66 offen sc1
    s_mov_b64 exec, -1
L_nos_22:
    v_lshlrev_b32 v24, 2, v1
    v_add_u32 v24, 140288, v24
    v_mov_b32 v25, 140360
    ds_read_b32 v84, v24
    ds_read_b32 v85, v25
    s_waitcnt lgkmcnt(0)
    v_cmp_lt_u32 vcc, 0x80, v84
    s_and_b32 s65, vcc_lo, 0x3ff
    v_readfirstlane_b32 s66, v85
    v_cmp_lt_u32 vcc, 0x60, v84
    s_and_b32 s63, vcc_lo, 0x3ff
    s_or_b32 s65, s65, s66
    s_cmp_lg_u32 s65, 0
    s_cbranch_scc1 L_slow
    v_add_u32 v84, 31, v84
    v_lshrrev_b32 v84, 5, v84
    s_mul_i32 s67, s43, 5
    s_mov_b32 s66, s67
    v_readlane_b32 s98, v84, s66
    s_add_u32 s66, s66, 1
    v_readlane_b32 s99, v84, s66
    s_add_u32 s66, s66, 1
    v_readlane_b32 s100, v84, s66
    s_add_u32 s66, s66, 1
    v_readlane_b32 s101, v84, s66
    s_add_u32 s66, s66, 1
    v_readlane_b32 s92, v84, s66
    s_lshl_b32 s67, s67, 9
    v_mov_b32 v11, 5120
    s_mov_b32 s65, 0
    v_subrev_u32 v24, s65, v1
    v_lshlrev_b32 v24, 7, v24
    v_cmp_le_u32 vcc, s65, v1
    v_add_u32 v24, s67, v24
    s_add_u32 s65, s65, s98
    s_add_u32 s67, s67, 512
    v_cndmask_b32 v11, v11, v24, vcc
    v_subrev_u32 v24, s65, v1
    v_lshlrev_b32 v24, 7, v24
    v_cmp_le_u32 vcc, s65, v1
    v_add_u32 v24, s67, v24
    s_add_u32 s65, s65, s99
    s_add_u32 s67, s67, 512
    v_cndmask_b32 v11, v11, v24, vcc
    v_subrev_u32 v24, s65, v1
    v_lshlrev_b32 v24, 7, v24
    v_cmp_le_u32 vcc, s65, v1
    v_add_u32 v24, s67, v24
    s_add_u32 s65, s65, s100
    s_add_u32 s67, s67, 512
    v_cndmask_b32 v11, v11, v24, vcc
    v_subrev_u32 v24, s65, v1
    v_lshlrev_b32 v24, 7, v24
    v_cmp_le_u32 vcc, s65, v1
    v_add_u32 v24, s67, v24
    s_add_u32 s65, s65, s101
    s_add_u32 s67, s67, 512
    v_cndmask_b32 v11, v11, v24, vcc
    v_subrev_u32 v24, s65, v1
    v_lshlrev_b32 v24, 7, v24
    v_cmp_le_u32 vcc, s65, v1
    v_add_u32 v24, s67, v24
    s_add_u32 s65, s65, s92
    s_add_u32 s67, s67, 512
    v_cndmask_b32 v11, v11, v24, vcc
    v_mov_b32 v24, 5120
    v_cmp_le_u32 vcc, s65, v1
    s_mov_b32 s24, s65
    s_lshl_b32 s49, s92, 4
    s_or_b32 s49, s49, s101
    s_lshl_b32 s49, s49, 4
    s_or_b32 s49, s49, s100
    s_lshl_b32 s49, s49, 4
    s_or_b32 s49, s49, s99
    s_lshl_b32 s49, s49, 4
    s_or_b32 s49, s49, s98
    v_cndmask_b32 v11, v11, v24, vcc
    s_nop 0
    v_readlane_b32 s65, v11, 0
    s_nop 1
    v_add_u32 v30, s65, v8
    ds_read_b128 v[92:95], v30
    v_readlane_b32 s65, v11, 1
    s_nop 1
    v_add_u32 v30, s65, v8
    ds_read_b128 v[96:99], v30
    v_readlane_b32 s65, v11, 2
    s_nop 1
    v_add_u32 v30, s65, v8
    ds_read_b128 v[100:103], v30
    s_mov_b32 s58, 3
    s_mov_b32 s57, 0
    s_waitcnt lgkmcnt(0)
    s_add_u32 m0, s56, 0
    v_and_or_b32 v92, v92, s97, v9
    v_and_or_b32 v93, v93, s97, v10
    v_and_or_b32 v94, v94, s97, v9
    v_and_or_b32 v95, v95, s97, v10
    buffer_load_dwordx4 v92, s[4:7], s52 offen offset:0 lds
    buffer_load_dwordx4 v93, s[4:7], s53 offen offset:1024 lds
    buffer_load_dwordx4 v94, s[4:7], s54 offen offset:2048 lds
    buffer_load_dwordx4 v95, s[4:7], s55 offen offset:3072 lds
    s_add_u32 m0, s56, 4096
    v_and_or_b32 v96, v96, s97, v9
    v_and_or_b32 v97, v97, s97, v10
    v_and_or_b32 v98, v98, s97, v9
    v_and_or_b32 v99, v99, s97, v10
    buffer_load_dwordx4 v96, s[4:7], s52 offen offset:0 lds
    buffer_load_dwordx4 v97, s[4:7], s53 offen offset:1024 lds
    buffer_load_dwordx4 v98, s[4:7], s54 offen offset:2048 lds
    buffer_load_dwordx4 v99, s[4:7], s55 offen offset:3072 lds
    s_add_u32 m0, s56, 8192
    v_and_or_b32 v100, v100, s97, v9
    v_and_or_b32 v101, v101, s97, v10
    v_and_or_b32 v102, v102, s97, v9
    v_and_or_b32 v103, v103, s97, v10
    buffer_load_dwordx4 v100, s[4:7], s52 offen offset:0 lds
    buffer_load_dwordx4 v101, s[4:7], s53 offen offset:1024 lds
    buffer_load_dwordx4 v102, s[4:7], s54 offen offset:2048 lds
    buffer_load_dwordx4 v103, s[4:7], s55 offen offset:3072 lds
    v_readlane_b32 s65, v11, s58
    s_add_u32 s58, s58, 1
    s_nop 0
    v_add_u32 v30, s65, v8
    ds_read_b128 v[12:15], v30
    s_waitcnt lgkmcnt(0)
    s_barrier
    s_add_u32 s66, s3, 0
    buffer_load_dwordx4 v[112:115], v23, s[12:15], s66 offen offset:0 sc1
    buffer_load_dwordx4 v[116:119], v23, s[12:15], s66 offen offset:1024 sc1
    buffer_load_dwordx4 v[120:123], v23, s[12:15], s66 offen offset:2048 sc1
    buffer_load_dwordx4 v[124:127], v23, s[12:15], s66 offen offset:3072 sc1
    s_add_u32 s66, s3, 4096
    buffer_load_dwordx4 v[128:131], v23, s[12:15], s66 offen offset:0 sc1
    buffer_load_dwordx4 v[132:135], v23, s[12:15], s66 offen offset:1024 sc1
    buffer_load_dwordx4 v[136:139], v23, s[12:15], s66 offen offset:2048 sc1
    buffer_load_dwordx4 v[140:143], v23, s[12:15], s66 offen offset:3072 sc1
    ds_read_b32 v34, v105
    ds_read_b32 v32, v106
    ds_read_b32 v35, v109
    ds_read_b32 v33, v110
    s_mov_b32 s92, 4259840
    s_movk_i32 s99, 0x3f0
    v_mov_b32 v29, 139264
    s_waitcnt lgkmcnt(0)
    v_cmpx_gt_u32 vcc, v34, v104
    v_lshrrev_b32 v24, 5, v32
    v_and_b32 v36, 0x3fff0, v24
    v_lshlrev_b32 v24, 1, v32
    v_and_or_b32 v38, v24, s99, v29
    buffer_load_dwordx4 v[40:43], v36, s[12:15], s92 offen sc1
    ds_read_b128 v[48:51], v38
    s_mov_b64 exec, -1
    v_cmpx_gt_u32 vcc, v35, v108
    v_lshrrev_b32 v24, 5, v33
    v_and_b32 v37, 0x3fff0, v24
    v_lshlrev_b32 v24, 1, v33
    v_and_or_b32 v39, v24, s99, v29
    buffer_load_dwordx4 v[44:47], v37, s[12:15], s92 offen sc1
    ds_read_b128 v[52:55], v39
    s_mov_b64 exec, -1
    s_waitcnt vmcnt(0) lgkmcnt(0)
    v_mov_b32 v29, 0
    v_cmpx_gt_u32 vcc, v34, v104
    v_xor_b32 v25, s44, v40
    v_xor_b32 v26, s45, v41
    v_or3_b32 v29, v29, v25, v26
    v_xor_b32 v25, s46, v42
    v_xor_b32 v26, s47, v43
    v_or3_b32 v29, v29, v25, v26
    s_mov_b64 exec, -1
    v_cmpx_gt_u32 vcc, v35, v108
    v_xor_b32 v25, s44, v44
    v_xor_b32 v26, s45, v45
    v_or3_b32 v29, v29, v25, v26
    v_xor_b32 v25, s46, v46
    v_xor_b32 v26, s47, v47
    v_or3_b32 v29, v29, v25, v26
    s_mov_b64 exec, -1
    v_and_b32 v29, 0xfff, v29
    v_cmp_ne_u32 vcc, 0, v29
    s_cbranch_vccnz L_s_retry_23
L_s_ok_24:
    s_mov_b32 s92, 0xfffff000
    v_cmpx_gt_u32 vcc, v34, v104
    v_and_b32 v40, s92, v40
    v_and_b32 v41, s92, v41
    v_and_b32 v42, s92, v42
    v_and_b32 v43, s92, v43
    v_pk_add_f32 v[40:41], v[40:41], v[48:49]
    v_pk_add_f32 v[42:43], v[42:43], v[50:51]
    v_mul_f32 v48, 0x3e4ccccd, v40
    v_mul_f32 v49, 0x3e4ccccd, v41
    v_mul_f32 v50, 0x3e4ccccd, v42
    v_mul_f32 v51, 0x3e4ccccd, v43
    v_max_f32 v40, v40, v48
    v_max_f32 v41, v41, v49
    v_max_f32 v42, v42, v50
    v_max_f32 v43, v43, v51
    v_exp_f32 v40, v40
    v_exp_f32 v41, v41
    v_exp_f32 v42, v42
    v_exp_f32 v43, v43
    v_bfe_u32 v24, v32, 3, 2
    v_lshl_add_u32 v24, v24, 6, v107
    v_cvt_pk_bf16_f32 v48, v40, v41
    v_cvt_pk_bf16_f32 v49, v42, v43
    ds_write_b16 v24, v48
    ds_write_b16_d16_hi v24, v48 offset:16
    ds_write_b16 v24, v49 offset:32
    ds_write_b16_d16_hi v24, v49 offset:48
    s_mov_b64 exec, -1
    v_cmpx_gt_u32 vcc, v35, v108
    v_and_b32 v44, s92, v44
    v_and_b32 v45, s92, v45
    v_and_b32 v46, s92, v46
    v_and_b32 v47, s92, v47
    v_pk_add_f32 v[44:45], v[44:45], v[52:53]
    v_pk_add_f32 v[46:47], v[46:47], v[54:55]
    v_mul_f32 v52, 0x3e4ccccd, v44
    v_mul_f32 v53, 0x3e4ccccd, v45
    v_mul_f32 v54, 0x3e4ccccd, v46
    v_mul_f32 v55, 0x3e4ccccd, v47
    v_max_f32 v44, v44, v52
    v_max_f32 v45, v45, v53
    v_max_f32 v46, v46, v54
    v_max_f32 v47, v47, v55
    v_exp_f32 v44, v44
    v_exp_f32 v45, v45
    v_exp_f32 v46, v46
    v_exp_f32 v47, v47
    v_bfe_u32 v24, v33, 3, 2
    v_lshl_add_u32 v24, v24, 6, v111
    v_cvt_pk_bf16_f32 v52, v44, v45
    v_cvt_pk_bf16_f32 v53, v46, v47
    ds_write_b16 v24, v52
    ds_write_b16_d16_hi v24, v52 offset:16
    ds_write_b16 v24, v53 offset:32
    ds_write_b16_d16_hi v24, v53 offset:48
    s_mov_b64 exec, -1
    s_cmp_lg_u32 s63, 0
    s_cbranch_scc1 L_rareC_25
L_rareCb_26:
    v_and_b32 v26, 15, v1
    v_lshrrev_b32 v92, 4, v1
    v_bfe_u32 v27, v26, 1, 2
    v_lshrrev_b32 v28, 3, v26
    v_lshl_add_u32 v93, v28, 2, v27
    v_and_b32 v30, 1, v26
    v_lshlrev_b32 v30, 3, v30
    s_mul_i32 s65, s41, 49152
    s_and_b32 s66, s48, 1
    s_lshl_b32 s67, s66, 13
    s_add_u32 s67, s67, s65
    s_lshl_b32 s66, s66, 12
    s_add_u32 s66, s66, s65
    v_lshl_add_u32 v94, v27, 8, v30
    v_lshl_add_u32 v94, v28, 10, v94
    v_add_u32 v94, s67, v94
    v_lshl_add_u32 v95, v27, 7, v30
    v_lshl_add_u32 v95, v28, 9, v95
    v_add_u32 v95, s66, v95
    v_lshrrev_b32 v25, 4, v1
    v_add_u32 v100, 0, v25
    v_xor_b32 v27, v26, v100
    v_lshlrev_b32 v27, 4, v27
    v_lshl_add_u32 v27, v25, 8, v27
    v_add_u32 v104, s65, v27
    v_and_b32 v27, 7, v26
    v_xor_b32 v27, v27, v100
    v_lshlrev_b32 v27, 4, v27
    v_lshl_add_u32 v27, v25, 7, v27
    v_add_u32 v106, s65, v27
    v_add_u32 v100, 4, v25
    v_xor_b32 v27, v26, v100
    v_lshlrev_b32 v27, 4, v27
    v_lshl_add_u32 v27, v25, 8, v27
    v_add_u32 v105, s65, v27
    v_and_b32 v27, 7, v26
    v_xor_b32 v27, v27, v100
    v_lshlrev_b32 v27, 4, v27
    v_lshl_add_u32 v27, v25, 7, v27
    v_add_u32 v107, s65, v27
    s_waitcnt lgkmcnt(0)
    s_barrier
    v_mov_b64 v[32:33], 0
    v_mov_b64 v[34:35], 0
    v_mov_b64 v[36:37], 0
    v_mov_b64 v[38:39], 0
    v_mov_b64 v[40:41], 0
    v_mov_b64 v[42:43], 0
    v_mov_b64 v[44:45], 0
    v_mov_b64 v[46:47], 0
    v_mov_b64 v[48:49], 0
    v_mov_b64 v[50:51], 0
    v_mov_b32 v24, 0x3f803f80
    v_mov_b32 v25, 0x3f803f80
    v_mov_b32 v26, 0x3f803f80
    v_mov_b32 v27, 0x3f803f80
    s_cmp_eq_u32 s41, 0
    s_cbranch_scc1 L_aprio_27
    s_setprio 3
L_aprio_27:
    s_cmp_eq_u32 s41, 1
    s_cbranch_scc1 L_lprio_28
    s_setprio 2
L_lprio_28:
    s_movk_i32 s94, 0x1000
    s_mov_b32 s60, 0
    s_mov_b32 s62, 0
    s_and_b32 s61, s49, 15
    s_lshr_b32 s49, s49, 4
    v_readlane_b32 s66, v11, s62
    s_add_u32 s62, s62, 1
    s_lshl_b32 s66, s66, 3
    v_add_u32 v100, s66, v6
    s_waitcnt vmcnt(8)
    ds_read_b128 v[16:19], v100
    ds_read_b64_tr_b16 v[240:241], v2
    ds_read_b64_tr_b16 v[242:243], v2 offset:512
    ds_read_b64_tr_b16 v[244:245], v3
    ds_read_b64_tr_b16 v[246:247], v3 offset:512
    ds_read_b64_tr_b16 v[248:249], v4
    ds_read_b64_tr_b16 v[250:251], v4 offset:512
    ds_read_b64_tr_b16 v[252:253], v5
    ds_read_b64_tr_b16 v[254:255], v5 offset:512
    s_cmp_eq_u32 s61, 0
    s_cbranch_scc1 L_agg_ge_30
L_agg_top_29:
    s_cmp_gt_u32 s58, s24
    s_cbranch_scc1 L_agg_tail_32
    s_waitcnt lgkmcnt(0)
    v_mfma_f32_16x16x32_bf16 v[48:51], v[16:19], v[24:27], v[48:51]
    v_and_or_b32 v12, v12, s97, v9
    v_and_or_b32 v13, v13, s97, v10
    v_and_or_b32 v14, v14, s97, v9
    v_and_or_b32 v15, v15, s97, v10
    s_add_u32 m0, s56, s57
    v_mfma_f32_16x16x32_bf16 v[32:35], v[16:19], v[240:243], v[32:35]
    buffer_load_dwordx4 v12, s[4:7], s52 offen offset:0 lds
    v_mfma_f32_16x16x32_bf16 v[36:39], v[16:19], v[244:247], v[36:39]
    buffer_load_dwordx4 v13, s[4:7], s53 offen offset:1024 lds
    v_mfma_f32_16x16x32_bf16 v[40:43], v[16:19], v[248:251], v[40:43]
    buffer_load_dwordx4 v14, s[4:7], s54 offen offset:2048 lds
    v_mfma_f32_16x16x32_bf16 v[44:47], v[16:19], v[252:255], v[44:47]
    buffer_load_dwordx4 v15, s[4:7], s55 offen offset:3072 lds
    v_readlane_b32 s65, v11, s58
    s_add_u32 s57, s57, 4096
    s_cmp_eq_u32 s57, 12288
    s_cselect_b32 s57, 0, s57
    s_cselect_b32 s59, s95, s94
    v_readlane_b32 s66, v11, s62
    s_add_u32 s62, s62, 1
    s_lshl_b32 s66, s66, 3
    v_add_u32 v100, s66, v6
    v_add_u32 v2, s59, v2
    v_add_u32 v3, s59, v3
    v_add_u32 v4, s59, v4
    v_add_u32 v5, s59, v5
    s_add_u32 s58, s58, 1
    v_add_u32 v30, s65, v8
    s_waitcnt vmcnt(8)
    ds_read_b128 v[16:19], v100
    ds_read_b64_tr_b16 v[240:241], v2
    ds_read_b64_tr_b16 v[242:243], v2 offset:512
    ds_read_b64_tr_b16 v[244:245], v3
    ds_read_b64_tr_b16 v[246:247], v3 offset:512
    ds_read_b64_tr_b16 v[248:249], v4
    ds_read_b64_tr_b16 v[250:251], v4 offset:512
    ds_read_b64_tr_b16 v[252:253], v5
    ds_read_b64_tr_b16 v[254:255], v5 offset:512
    ds_read_b128 v[12:15], v30
L_agg_ctl_33:
    s_sub_u32 s61, s61, 1
    s_cmp_lg_u32 s61, 0
    s_cbranch_scc1 L_agg_top_29
L_agg_ge_30:
    s_lshl_b32 s65, s60, 3
    s_add_u32 s60, s60, 1
    v_fmaak_f32 v48, 4.0, v48, 0x3189705f
    v_fmaak_f32 v49, 4.0, v49, 0x3189705f
    v_fmaak_f32 v50, 4.0, v50, 0x3189705f
    v_fmaak_f32 v51, 4.0, v51, 0x3189705f
    v_rcp_f32 v48, v48
    v_rcp_f32 v49, v49
    v_rcp_f32 v50, v50
    v_rcp_f32 v51, v51
    s_nop 0
    v_pk_mul_f32 v[32:33], v[32:33], v[48:49]
    v_pk_mul_f32 v[34:35], v[34:35], v[50:51]
    v_pk_mul_f32 v[36:37], v[36:37], v[48:49]
    v_pk_mul_f32 v[38:39], v[38:39], v[50:51]
    v_pk_mul_f32 v[40:41], v[40:41], v[48:49]
    v_pk_mul_f32 v[42:43], v[42:43], v[50:51]
    v_pk_mul_f32 v[44:45], v[44:45], v[48:49]
    v_pk_mul_f32 v[46:47], v[46:47], v[50:51]
    s_set_gpr_idx_on s65, gpr_idx(DST)
    s_nop 0
    v_cvt_pk_bf16_f32 v52, v32, v33
    v_cvt_pk_bf16_f32 v53, v34, v35
    v_cvt_pk_bf16_f32 v54, v36, v37
    v_cvt_pk_bf16_f32 v55, v38, v39
    v_cvt_pk_bf16_f32 v56, v40, v41
    v_cvt_pk_bf16_f32 v57, v42, v43
    v_cvt_pk_bf16_f32 v58, v44, v45
    v_cvt_pk_bf16_f32 v59, v46, v47
    s_set_gpr_idx_off
    v_mov_b64 v[32:33], 0
    v_mov_b64 v[34:35], 0
    v_mov_b64 v[36:37], 0
    v_mov_b64 v[38:39], 0
    v_mov_b64 v[40:41], 0
    v_mov_b64 v[42:43], 0
    v_mov_b64 v[44:45], 0
    v_mov_b64 v[46:47], 0
    v_mov_b64 v[48:49], 0
    v_mov_b64 v[50:51], 0
    s_cmp_eq_u32 s60, 5
    s_cbranch_scc1 L_agg_done_31
    s_and_b32 s61, s49, 15
    s_lshr_b32 s49, s49, 4
    s_cmp_lg_u32 s61, 0
    s_cbranch_scc1 L_agg_top_29
    s_branch L_agg_ge_30
L_agg_tail_32:
    s_waitcnt lgkmcnt(0)
    v_mfma_f32_16x16x32_bf16 v[48:51], v[16:19], v[24:27], v[48:51]
    v_mfma_f32_16x16x32_bf16 v[32:35], v[16:19], v[240:243], v[32:35]
    v_mfma_f32_16x16x32_bf16 v[36:39], v[16:19], v[244:247], v[36:39]
    v_mfma_f32_16x16x32_bf16 v[40:43], v[16:19], v[248:251], v[40:43]
    v_mfma_f32_16x16x32_bf16 v[44:47], v[16:19], v[252:255], v[44:47]
    s_add_u32 s57, s57, 4096
    s_cmp_eq_u32 s57, 12288
    s_cselect_b32 s57, 0, s57
    s_cselect_b32 s59, s95, s94
    v_readlane_b32 s66, v11, s62
    s_add_u32 s62, s62, 1
    s_lshl_b32 s66, s66, 3
    v_add_u32 v100, s66, v6
    v_add_u32 v2, s59, v2
    v_add_u32 v3, s59, v3
    v_add_u32 v4, s59, v4
    v_add_u32 v5, s59, v5
    s_waitcnt vmcnt(0)
    ds_read_b128 v[16:19], v100
    ds_read_b64_tr_b16 v[240:241], v2
    ds_read_b64_tr_b16 v[242:243], v2 offset:512
    ds_read_b64_tr_b16 v[244:245], v3
    ds_read_b64_tr_b16 v[246:247], v3 offset:512
    ds_read_b64_tr_b16 v[248:249], v4
    ds_read_b64_tr_b16 v[250:251], v4 offset:512
    ds_read_b64_tr_b16 v[252:253], v5
    ds_read_b64_tr_b16 v[254:255], v5 offset:512
    s_branch L_agg_ctl_33
L_agg_done_31:
L_aggw:
    s_waitcnt vmcnt(0) lgkmcnt(0)
    v_mov_b32 v28, s28
    v_mov_b32 v29, 1
    s_waitcnt lgkmcnt(0)
    s_mov_b64 exec, 1
    ds_add_u32 v28, v29 offset:4
    s_mov_b64 exec, -1
    s_add_u32 s66, s3, 8192
    buffer_load_dwordx4 v[144:147], v23, s[12:15], s66 offen offset:0 sc1
    buffer_load_dwordx4 v[148:151], v23, s[12:15], s66 offen offset:1024 sc1
    buffer_load_dwordx4 v[152:155], v23, s[12:15], s66 offen offset:2048 sc1
    buffer_load_dwordx4 v[156:159], v23, s[12:15], s66 offen offset:3072 sc1
    s_add_u32 s66, s3, 12288
    buffer_load_dwordx4 v[160:163], v23, s[12:15], s66 offen offset:0 sc1
    buffer_load_dwordx4 v[164:167], v23, s[12:15], s66 offen offset:1024 sc1
    buffer_load_dwordx4 v[168:171], v23, s[12:15], s66 offen offset:2048 sc1
    buffer_load_dwordx4 v[172:175], v23, s[12:15], s66 offen offset:3072 sc1
L_sync_34:
    ds_read_b32 v29, v28 offset:4
    s_waitcnt lgkmcnt(0)
    v_cmp_gt_u32 vcc, 4, v29
    s_cbranch_vccz L_syncd_35
    s_add_u32 s96, s96, 1
    s_cmp_lt_u32 s96, 1600000
    s_cbranch_scc1 L_sync_34
L_syncd_35:
    s_cmp_eq_u32 s43, 1
    s_cbranch_scc1 L_aggw_h1_37
    v_add_u32 v16, 0, v92
    v_xor_b32 v16, v16, v93
    v_lshl_add_u32 v16, v16, 4, v94
    ds_write_b64 v16, v[52:53] offset:0
    ds_write_b64 v16, v[54:55] offset:2048
    ds_write_b64 v16, v[56:57] offset:4096
    ds_write_b64 v16, v[58:59] offset:6144
    v_add_u32 v17, 4, v92
    v_xor_b32 v17, v17, v93
    v_lshl_add_u32 v17, v17, 4, v94
    ds_write_b64 v17, v[60:61] offset:0
    ds_write_b64 v17, v[62:63] offset:2048
    ds_write_b64 v17, v[64:65] offset:4096
    ds_write_b64 v17, v[66:67] offset:6144
    v_add_u32 v16, 8, v92
    v_xor_b32 v16, v16, v93
    v_lshl_add_u32 v16, v16, 4, v94
    ds_write_b64 v16, v[68:69] offset:0
    ds_write_b64 v16, v[70:71] offset:2048
    ds_write_b64 v16, v[72:73] offset:4096
    ds_write_b64 v16, v[74:75] offset:6144
    v_add_u32 v17, 12, v92
    v_xor_b32 v17, v17, v93
    v_lshl_add_u32 v17, v17, 4, v94
    ds_write_b64 v17, v[76:77] offset:0
    ds_write_b64 v17, v[78:79] offset:2048
    ds_write_b64 v17, v[80:81] offset:4096
    ds_write_b64 v17, v[82:83] offset:6144
    v_add_u32 v16, 0, v92
    v_xor_b32 v16, v16, v93
    v_lshl_add_u32 v16, v16, 4, v94
    ds_write_b64 v16, v[84:85] offset:16384
    ds_write_b64 v16, v[86:87] offset:18432
    ds_write_b64 v16, v[88:89] offset:20480
    ds_write_b64 v16, v[90:91] offset:22528
    s_branch L_aggw_end_36
L_aggw_h1_37:
    v_add_u32 v16, 4, v92
    v_xor_b32 v16, v16, v93
    v_lshl_add_u32 v16, v16, 4, v94
    ds_write_b64 v16, v[52:53] offset:16384
    ds_write_b64 v16, v[54:55] offset:18432
    ds_write_b64 v16, v[56:57] offset:20480
    ds_write_b64 v16, v[58:59] offset:22528
    v_add_u32 v17, 8, v92
    v_xor_b32 v17, v17, v93
    v_lshl_add_u32 v17, v17, 4, v94
    ds_write_b64 v17, v[60:61] offset:16384
    ds_write_b64 v17, v[62:63] offset:18432
    ds_write_b64 v17, v[64:65] offset:20480
    ds_write_b64 v17, v[66:67] offset:22528
    v_add_u32 v16, 12, v92
    v_xor_b32 v16, v16, v93
    v_lshl_add_u32 v16, v16, 4, v94
    ds_write_b64 v16, v[68:69] offset:16384
    ds_write_b64 v16, v[70:71] offset:18432
    ds_write_b64 v16, v[72:73] offset:20480
    ds_write_b64 v16, v[74:75] offset:22528
    v_add_u32 v17, 0, v92
    v_xor_b32 v17, v17, v93
    v_lshl_add_u32 v17, v17, 4, v95
    ds_write_b64 v17, v[76:77] offset:32768
    ds_write_b64 v17, v[78:79] offset:33792
    ds_write_b64 v17, v[80:81] offset:34816
    ds_write_b64 v17, v[82:83] offset:35840
    v_add_u32 v16, 4, v92
    v_xor_b32 v16, v16, v93
    v_lshl_add_u32 v16, v16, 4, v95
    ds_write_b64 v16, v[84:85] offset:32768
    ds_write_b64 v16, v[86:87] offset:33792
    ds_write_b64 v16, v[88:89] offset:34816
    ds_write_b64 v16, v[90:91] offset:35840
L_aggw_end_36:
    s_add_u32 s66, s3, 16384
    buffer_load_dwordx4 v[176:179], v23, s[12:15], s66 offen offset:0 sc1
    buffer_load_dwordx4 v[180:183], v23, s[12:15], s66 offen offset:1024 sc1
    buffer_load_dwordx4 v[184:187], v23, s[12:15], s66 offen offset:2048 sc1
    buffer_load_dwordx4 v[188:191], v23, s[12:15], s66 offen offset:3072 sc1
    v_mov_b32 v28, s28
    v_mov_b32 v29, 1
    s_waitcnt lgkmcnt(0)
    s_mov_b64 exec, 1
    ds_add_u32 v28, v29 offset:8
    s_mov_b64 exec, -1
L_sync_38:
    ds_read_b32 v29, v28 offset:8
    s_waitcnt lgkmcnt(0)
    v_cmp_gt_u32 vcc, 4, v29
    s_cbranch_vccz L_syncd_39
    s_add_u32 s96, s96, 1
    s_cmp_lt_u32 s96, 1600000
    s_cbranch_scc1 L_sync_38
L_syncd_39:
    s_cmp_eq_u32 s41, 0
    s_cbranch_scc1 L_gpa_40
    s_setprio 1
    s_branch L_gpb_41
L_gpa_40:
    s_setprio 0
L_gpb_41:
    v_mov_b32 v88, 0
    v_mov_b32 v89, 0
    v_mov_b32 v90, 0
    v_mov_b32 v91, 0
    v_mov_b32 v100, 0
    v_mov_b32 v101, 0
    v_mov_b32 v102, 0
    v_mov_b32 v103, 0
    s_mov_b32 s70, 0x00ff00ff
    s_mov_b32 s71, 0x00ff00ff
    ds_read_b128 v[80:83], v104 offset:0
    ds_read_b128 v[84:87], v104 offset:16384
    s_mov_b64 exec, s[70:71]
    ds_read_b128 v[88:91], v106 offset:32768
    s_mov_b64 exec, -1
    s_waitcnt lgkmcnt(0)
    v_mfma_f32_16x16x32_bf16 v[32:35], v[112:115], v[80:83], 0
    ds_read_b128 v[92:95], v105 offset:1024
    v_mfma_f32_16x16x32_bf16 v[36:39], v[116:119], v[80:83], 0
    ds_read_b128 v[96:99], v105 offset:17408
    v_mfma_f32_16x16x32_bf16 v[40:43], v[120:123], v[80:83], 0
    s_mov_b64 exec, s[70:71]
    ds_read_b128 v[100:103], v107 offset:33280
    s_mov_b64 exec, -1
    v_mfma_f32_16x16x32_bf16 v[44:47], v[124:127], v[80:83], 0
    s_add_u32 s66, s3, 20480
    v_mfma_f32_16x16x32_bf16 v[48:51], v[112:115], v[84:87], 0
    buffer_load_dwordx4 v[192:195], v23, s[12:15], s66 offen offset:0 sc1
    v_mfma_f32_16x16x32_bf16 v[52:55], v[116:119], v[84:87], 0
    buffer_load_dwordx4 v[196:199], v23, s[12:15], s66 offen offset:1024 sc1
    v_mfma_f32_16x16x32_bf16 v[56:59], v[120:123], v[84:87], 0
    buffer_load_dwordx4 v[200:203], v23, s[12:15], s66 offen offset:2048 sc1
    v_mfma_f32_16x16x32_bf16 v[60:63], v[124:127], v[84:87], 0
    buffer_load_dwordx4 v[204:207], v23, s[12:15], s66 offen offset:3072 sc1
    v_mfma_f32_16x16x32_bf16 v[64:67], v[112:115], v[88:91], 0
    v_mfma_f32_16x16x32_bf16 v[68:71], v[116:119], v[88:91], 0
    v_mfma_f32_16x16x32_bf16 v[72:75], v[120:123], v[88:91], 0
    v_mfma_f32_16x16x32_bf16 v[76:79], v[124:127], v[88:91], 0
    s_waitcnt lgkmcnt(0)
    v_mfma_f32_16x16x32_bf16 v[32:35], v[128:131], v[92:95], v[32:35]
    ds_read_b128 v[80:83], v104 offset:2048
    v_mfma_f32_16x16x32_bf16 v[36:39], v[132:135], v[92:95], v[36:39]
    ds_read_b128 v[84:87], v104 offset:18432
    v_mfma_f32_16x16x32_bf16 v[40:43], v[136:139], v[92:95], v[40:43]
    s_mov_b64 exec, s[70:71]
    ds_read_b128 v[88:91], v106 offset:33792
    s_mov_b64 exec, -1
    v_mfma_f32_16x16x32_bf16 v[44:47], v[140:143], v[92:95], v[44:47]
    s_add_u32 s66, s3, 24576
    v_mfma_f32_16x16x32_bf16 v[48:51], v[128:131], v[96:99], v[48:51]
    buffer_load_dwordx4 v[208:211], v23, s[12:15], s66 offen offset:0 sc1
    v_mfma_f32_16x16x32_bf16 v[52:55], v[132:135], v[96:99], v[52:55]
    buffer_load_dwordx4 v[212:215], v23, s[12:15], s66 offen offset:1024 sc1
    v_mfma_f32_16x16x32_bf16 v[56:59], v[136:139], v[96:99], v[56:59]
    buffer_load_dwordx4 v[216:219], v23, s[12:15], s66 offen offset:2048 sc1
    v_mfma_f32_16x16x32_bf16 v[60:63], v[140:143], v[96:99], v[60:63]
    buffer_load_dwordx4 v[220:223], v23, s[12:15], s66 offen offset:3072 sc1
    v_mfma_f32_16x16x32_bf16 v[64:67], v[128:131], v[100:103], v[64:67]
    v_mfma_f32_16x16x32_bf16 v[68:71], v[132:135], v[100:103], v[68:71]
    v_mfma_f32_16x16x32_bf16 v[72:75], v[136:139], v[100:103], v[72:75]
    v_mfma_f32_16x16x32_bf16 v[76:79], v[140:143], v[100:103], v[76:79]
    s_waitcnt vmcnt(16) lgkmcnt(0)
    v_mfma_f32_16x16x32_bf16 v[32:35], v[144:147], v[80:83], v[32:35]
    ds_read_b128 v[92:95], v105 offset:3072
    v_mfma_f32_16x16x32_bf16 v[36:39], v[148:151], v[80:83], v[36:39]
    ds_read_b128 v[96:99], v105 offset:19456
    v_mfma_f32_16x16x32_bf16 v[40:43], v[152:155], v[80:83], v[40:43]
    s_mov_b64 exec, s[70:71]
    ds_read_b128 v[100:103], v107 offset:34304
    s_mov_b64 exec, -1
    v_mfma_f32_16x16x32_bf16 v[44:47], v[156:159], v[80:83], v[44:47]
    s_add_u32 s66, s3, 28672
    v_mfma_f32_16x16x32_bf16 v[48:51], v[144:147], v[84:87], v[48:51]
    buffer_load_dwordx4 v[224:227], v23, s[12:15], s66 offen offset:0 sc1
    v_mfma_f32_16x16x32_bf16 v[52:55], v[148:151], v[84:87], v[52:55]
    buffer_load_dwordx4 v[228:231], v23, s[12:15], s66 offen offset:1024 sc1
    v_mfma_f32_16x16x32_bf16 v[56:59], v[152:155], v[84:87], v[56:59]
    buffer_load_dwordx4 v[232:235], v23, s[12:15], s66 offen offset:2048 sc1
    v_mfma_f32_16x16x32_bf16 v[60:63], v[156:159], v[84:87], v[60:63]
    buffer_load_dwordx4 v[236:239], v23, s[12:15], s66 offen offset:3072 sc1
    v_mfma_f32_16x16x32_bf16 v[64:67], v[144:147], v[88:91], v[64:67]
    v_mfma_f32_16x16x32_bf16 v[68:71], v[148:151], v[88:91], v[68:71]
    v_mfma_f32_16x16x32_bf16 v[72:75], v[152:155], v[88:91], v[72:75]
    v_mfma_f32_16x16x32_bf16 v[76:79], v[156:159], v[88:91], v[76:79]
    s_waitcnt vmcnt(16) lgkmcnt(0)
    v_mfma_f32_16x16x32_bf16 v[32:35], v[160:163], v[92:95], v[32:35]
    ds_read_b128 v[80:83], v104 offset:4096
    v_mfma_f32_16x16x32_bf16 v[36:39], v[164:167], v[92:95], v[36:39]
    ds_read_b128 v[84:87], v104 offset:20480
    v_mfma_f32_16x16x32_bf16 v[40:43], v[168:171], v[92:95], v[40:43]
    s_mov_b64 exec, s[70:71]
    ds_read_b128 v[88:91], v106 offset:34816
    s_mov_b64 exec, -1
    v_mfma_f32_16x16x32_bf16 v[44:47], v[172:175], v[92:95], v[44:47]
    s_add_u32 s66, s3, 32768
    v_mfma_f32_16x16x32_bf16 v[48:51], v[160:163], v[96:99], v[48:51]
    buffer_load_dwordx4 v[112:115], v23, s[12:15], s66 offen offset:0 sc1
    v_mfma_f32_16x16x32_bf16 v[52:55], v[164:167], v[96:99], v[52:55]
    buffer_load_dwordx4 v[116:119], v23, s[12:15], s66 offen offset:1024 sc1
    v_mfma_f32_16x16x32_bf16 v[56:59], v[168:171], v[96:99], v[56:59]
    buffer_load_dwordx4 v[120:123], v23, s[12:15], s66 offen offset:2048 sc1
    v_mfma_f32_16x16x32_bf16 v[60:63], v[172:175], v[96:99], v[60:63]
    buffer_load_dwordx4 v[124:127], v23, s[12:15], s66 offen offset:3072 sc1
    v_mfma_f32_16x16x32_bf16 v[64:67], v[160:163], v[100:103], v[64:67]
    v_mfma_f32_16x16x32_bf16 v[68:71], v[164:167], v[100:103], v[68:71]
    v_mfma_f32_16x16x32_bf16 v[72:75], v[168:171], v[100:103], v[72:75]
    v_mfma_f32_16x16x32_bf16 v[76:79], v[172:175], v[100:103], v[76:79]
    s_waitcnt vmcnt(16) lgkmcnt(0)
    v_mfma_f32_16x16x32_bf16 v[32:35], v[176:179], v[80:83], v[32:35]
    ds_read_b128 v[92:95], v105 offset:5120
    v_mfma_f32_16x16x32_bf16 v[36:39], v[180:183], v[80:83], v[36:39]
    ds_read_b128 v[96:99], v105 offset:21504
    v_mfma_f32_16x16x32_bf16 v[40:43], v[184:187], v[80:83], v[40:43]
    s_mov_b64 exec, s[70:71]
    ds_read_b128 v[100:103], v107 offset:35328
    s_mov_b64 exec, -1
    v_mfma_f32_16x16x32_bf16 v[44:47], v[188:191], v[80:83], v[44:47]
    s_add_u32 s66, s3, 36864
    v_mfma_f32_16x16x32_bf16 v[48:51], v[176:179], v[84:87], v[48:51]
    buffer_load_dwordx4 v[128:131], v23, s[12:15], s66 offen offset:0 sc1
    v_mfma_f32_16x16x32_bf16 v[52:55], v[180:183], v[84:87], v[52:55]
    buffer_load_dwordx4 v[132:135], v23, s[12:15], s66 offen offset:1024 sc1
    v_mfma_f32_16x16x32_bf16 v[56:59], v[184:187], v[84:87], v[56:59]
    buffer_load_dwordx4 v[136:139], v23, s[12:15], s66 offen offset:2048 sc1
    v_mfma_f32_16x16x32_bf16 v[60:63], v[188:191], v[84:87], v[60:63]
    buffer_load_dwordx4 v[140:143], v23, s[12:15], s66 offen offset:3072 sc1
    v_mfma_f32_16x16x32_bf16 v[64:67], v[176:179], v[88:91], v[64:67]
    v_mfma_f32_16x16x32_bf16 v[68:71], v[180:183], v[88:91], v[68:71]
    v_mfma_f32_16x16x32_bf16 v[72:75], v[184:187], v[88:91], v[72:75]
    v_mfma_f32_16x16x32_bf16 v[76:79], v[188:191], v[88:91], v[76:79]
    s_waitcnt vmcnt(16) lgkmcnt(0)
    v_mfma_f32_16x16x32_bf16 v[32:35], v[192:195], v[92:95], v[32:35]
    ds_read_b128 v[80:83], v104 offset:6144
    v_mfma_f32_16x16x32_bf16 v[36:39], v[196:199], v[92:95], v[36:39]
    ds_read_b128 v[84:87], v104 offset:22528
    v_mfma_f32_16x16x32_bf16 v[40:43], v[200:203], v[92:95], v[40:43]
    s_mov_b64 exec, s[70:71]
    ds_read_b128 v[88:91], v106 offset:35840
    s_mov_b64 exec, -1
    v_mfma_f32_16x16x32_bf16 v[44:47], v[204:207], v[92:95], v[44:47]
    s_add_u32 s66, s3, 40960
    v_mfma_f32_16x16x32_bf16 v[48:51], v[192:195], v[96:99], v[48:51]
    buffer_load_dwordx4 v[144:147], v23, s[12:15], s66 offen offset:0 sc1
    v_mfma_f32_16x16x32_bf16 v[52:55], v[196:199], v[96:99], v[52:55]
    buffer_load_dwordx4 v[148:151], v23, s[12:15], s66 offen offset:1024 sc1
    v_mfma_f32_16x16x32_bf16 v[56:59], v[200:203], v[96:99], v[56:59]
    buffer_load_dwordx4 v[152:155], v23, s[12:15], s66 offen offset:2048 sc1
    v_mfma_f32_16x16x32_bf16 v[60:63], v[204:207], v[96:99], v[60:63]
    buffer_load_dwordx4 v[156:159], v23, s[12:15], s66 offen offset:3072 sc1
    v_mfma_f32_16x16x32_bf16 v[64:67], v[192:195], v[100:103], v[64:67]
    v_mfma_f32_16x16x32_bf16 v[68:71], v[196:199], v[100:103], v[68:71]
    v_mfma_f32_16x16x32_bf16 v[72:75], v[200:203], v[100:103], v[72:75]
    v_mfma_f32_16x16x32_bf16 v[76:79], v[204:207], v[100:103], v[76:79]
    s_waitcnt vmcnt(16) lgkmcnt(0)
    v_mfma_f32_16x16x32_bf16 v[32:35], v[208:211], v[80:83], v[32:35]
    ds_read_b128 v[92:95], v105 offset:7168
    v_mfma_f32_16x16x32_bf16 v[36:39], v[212:215], v[80:83], v[36:39]
    ds_read_b128 v[96:99], v105 offset:23552
    v_mfma_f32_16x16x32_bf16 v[40:43], v[216:219], v[80:83], v[40:43]
    s_mov_b64 exec, s[70:71]
    ds_read_b128 v[100:103], v107 offset:36352
    s_mov_b64 exec, -1
    v_mfma_f32_16x16x32_bf16 v[44:47], v[220:223], v[80:83], v[44:47]
    s_add_u32 s66, s3, 45056
    v_mfma_f32_16x16x32_bf16 v[48:51], v[208:211], v[84:87], v[48:51]
    buffer_load_dwordx4 v[160:163], v23, s[12:15], s66 offen offset:0 sc1
    v_mfma_f32_16x16x32_bf16 v[52:55], v[212:215], v[84:87], v[52:55]
    buffer_load_dwordx4 v[164:167], v23, s[12:15], s66 offen offset:1024 sc1
    v_mfma_f32_16x16x32_bf16 v[56:59], v[216:219], v[84:87], v[56:59]
    buffer_load_dwordx4 v[168:171], v23, s[12:15], s66 offen offset:2048 sc1
    v_mfma_f32_16x16x32_bf16 v[60:63], v[220:223], v[84:87], v[60:63]
    buffer_load_dwordx4 v[172:175], v23, s[12:15], s66 offen offset:3072 sc1
    v_mfma_f32_16x16x32_bf16 v[64:67], v[208:211], v[88:91], v[64:67]
    v_mfma_f32_16x16x32_bf16 v[68:71], v[212:215], v[88:91], v[68:71]
    v_mfma_f32_16x16x32_bf16 v[72:75], v[216:219], v[88:91], v[72:75]
    v_mfma_f32_16x16x32_bf16 v[76:79], v[220:223], v[88:91], v[76:79]
    s_waitcnt vmcnt(16) lgkmcnt(0)
    v_mfma_f32_16x16x32_bf16 v[32:35], v[224:227], v[92:95], v[32:35]
    ds_read_b128 v[80:83], v104 offset:8192
    v_mfma_f32_16x16x32_bf16 v[36:39], v[228:231], v[92:95], v[36:39]
    ds_read_b128 v[84:87], v104 offset:24576
    v_mfma_f32_16x16x32_bf16 v[40:43], v[232:235], v[92:95], v[40:43]
    s_mov_b64 exec, s[70:71]
    ds_read_b128 v[88:91], v106 offset:36864
    s_mov_b64 exec, -1
    v_mfma_f32_16x16x32_bf16 v[44:47], v[236:239], v[92:95], v[44:47]
    s_add_u32 s66, s3, 49152
    v_mfma_f32_16x16x32_bf16 v[48:51], v[224:227], v[96:99], v[48:51]
    buffer_load_dwordx4 v[176:179], v23, s[12:15], s66 offen offset:0 sc1
    v_mfma_f32_16x16x32_bf16 v[52:55], v[228:231], v[96:99], v[52:55]
    buffer_load_dwordx4 v[180:183], v23, s[12:15], s66 offen offset:1024 sc1
    v_mfma_f32_16x16x32_bf16 v[56:59], v[232:235], v[96:99], v[56:59]
    buffer_load_dwordx4 v[184:187], v23, s[12:15], s66 offen offset:2048 sc1
    v_mfma_f32_16x16x32_bf16 v[60:63], v[236:239], v[96:99], v[60:63]
    buffer_load_dwordx4 v[188:191], v23, s[12:15], s66 offen offset:3072 sc1
    v_mfma_f32_16x16x32_bf16 v[64:67], v[224:227], v[100:103], v[64:67]
    v_mfma_f32_16x16x32_bf16 v[68:71], v[228:231], v[100:103], v[68:71]
    v_mfma_f32_16x16x32_bf16 v[72:75], v[232:235], v[100:103], v[72:75]
    v_mfma_f32_16x16x32_bf16 v[76:79], v[236:239], v[100:103], v[76:79]
    s_waitcnt vmcnt(16) lgkmcnt(0)
    v_mfma_f32_16x16x32_bf16 v[32:35], v[112:115], v[80:83], v[32:35]
    ds_read_b128 v[92:95], v105 offset:9216
    v_mfma_f32_16x16x32_bf16 v[36:39], v[116:119], v[80:83], v[36:39]
    ds_read_b128 v[96:99], v105 offset:25600
    v_mfma_f32_16x16x32_bf16 v[40:43], v[120:123], v[80:83], v[40:43]
    s_mov_b64 exec, s[70:71]
    ds_read_b128 v[100:103], v107 offset:37376
    s_mov_b64 exec, -1
    v_mfma_f32_16x16x32_bf16 v[44:47], v[124:127], v[80:83], v[44:47]
    s_add_u32 s66, s3, 53248
    v_mfma_f32_16x16x32_bf16 v[48:51], v[112:115], v[84:87], v[48:51]
    buffer_load_dwordx4 v[192:195], v23, s[12:15], s66 offen offset:0 sc1
    v_mfma_f32_16x16x32_bf16 v[52:55], v[116:119], v[84:87], v[52:55]
    buffer_load_dwordx4 v[196:199], v23, s[12:15], s66 offen offset:1024 sc1
    v_mfma_f32_16x16x32_bf16 v[56:59], v[120:123], v[84:87], v[56:59]
    buffer_load_dwordx4 v[200:203], v23, s[12:15], s66 offen offset:2048 sc1
    v_mfma_f32_16x16x32_bf16 v[60:63], v[124:127], v[84:87], v[60:63]
    buffer_load_dwordx4 v[204:207], v23, s[12:15], s66 offen offset:3072 sc1
    v_mfma_f32_16x16x32_bf16 v[64:67], v[112:115], v[88:91], v[64:67]
    v_mfma_f32_16x16x32_bf16 v[68:71], v[116:119], v[88:91], v[68:71]
    v_mfma_f32_16x16x32_bf16 v[72:75], v[120:123], v[88:91], v[72:75]
    v_mfma_f32_16x16x32_bf16 v[76:79], v[124:127], v[88:91], v[76:79]
    s_waitcnt vmcnt(16) lgkmcnt(0)
    v_mfma_f32_16x16x32_bf16 v[32:35], v[128:131], v[92:95], v[32:35]
    ds_read_b128 v[80:83], v104 offset:10240
    v_mfma_f32_16x16x32_bf16 v[36:39], v[132:135], v[92:95], v[36:39]
    ds_read_b128 v[84:87], v104 offset:26624
    v_mfma_f32_16x16x32_bf16 v[40:43], v[136:139], v[92:95], v[40:43]
    s_mov_b64 exec, s[70:71]
    ds_read_b128 v[88:91], v106 offset:37888
    s_mov_b64 exec, -1
    v_mfma_f32_16x16x32_bf16 v[44:47], v[140:143], v[92:95], v[44:47]
    s_add_u32 s66, s3, 57344
    v_mfma_f32_16x16x32_bf16 v[48:51], v[128:131], v[96:99], v[48:51]
    buffer_load_dwordx4 v[208:211], v23, s[12:15], s66 offen offset:0 sc1
    v_mfma_f32_16x16x32_bf16 v[52:55], v[132:135], v[96:99], v[52:55]
    buffer_load_dwordx4 v[212:215], v23, s[12:15], s66 offen offset:1024 sc1
    v_mfma_f32_16x16x32_bf16 v[56:59], v[136:139], v[96:99], v[56:59]
    buffer_load_dwordx4 v[216:219], v23, s[12:15], s66 offen offset:2048 sc1
    v_mfma_f32_16x16x32_bf16 v[60:63], v[140:143], v[96:99], v[60:63]
    buffer_load_dwordx4 v[220:223], v23, s[12:15], s66 offen offset:3072 sc1
    v_mfma_f32_16x16x32_bf16 v[64:67], v[128:131], v[100:103], v[64:67]
    v_mfma_f32_16x16x32_bf16 v[68:71], v[132:135], v[100:103], v[68:71]
    v_mfma_f32_16x16x32_bf16 v[72:75], v[136:139], v[100:103], v[72:75]
    v_mfma_f32_16x16x32_bf16 v[76:79], v[140:143], v[100:103], v[76:79]
    s_waitcnt vmcnt(16) lgkmcnt(0)
    v_mfma_f32_16x16x32_bf16 v[32:35], v[144:147], v[80:83], v[32:35]
    ds_read_b128 v[92:95], v105 offset:11264
    v_mfma_f32_16x16x32_bf16 v[36:39], v[148:151], v[80:83], v[36:39]
    ds_read_b128 v[96:99], v105 offset:27648
    v_mfma_f32_16x16x32_bf16 v[40:43], v[152:155], v[80:83], v[40:43]
    s_mov_b64 exec, s[70:71]
    ds_read_b128 v[100:103], v107 offset:38400
    s_mov_b64 exec, -1
    v_mfma_f32_16x16x32_bf16 v[44:47], v[156:159], v[80:83], v[44:47]
    s_add_u32 s66, s3, 61440
    v_mfma_f32_16x16x32_bf16 v[48:51], v[144:147], v[84:87], v[48:51]
    buffer_load_dwordx4 v[224:227], v23, s[12:15], s66 offen offset:0 sc1
    v_mfma_f32_16x16x32_bf16 v[52:55], v[148:151], v[84:87], v[52:55]
    buffer_load_dwordx4 v[228:231], v23, s[12:15], s66 offen offset:1024 sc1
    v_mfma_f32_16x16x32_bf16 v[56:59], v[152:155], v[84:87], v[56:59]
    buffer_load_dwordx4 v[232:235], v23, s[12:15], s66 offen offset:2048 sc1
    v_mfma_f32_16x16x32_bf16 v[60:63], v[156:159], v[84:87], v[60:63]
    buffer_load_dwordx4 v[236:239], v23, s[12:15], s66 offen offset:3072 sc1
    v_mfma_f32_16x16x32_bf16 v[64:67], v[144:147], v[88:91], v[64:67]
    v_mfma_f32_16x16x32_bf16 v[68:71], v[148:151], v[88:91], v[68:71]
    v_mfma_f32_16x16x32_bf16 v[72:75], v[152:155], v[88:91], v[72:75]
    v_mfma_f32_16x16x32_bf16 v[76:79], v[156:159], v[88:91], v[76:79]
    s_waitcnt vmcnt(16) lgkmcnt(0)
    v_mfma_f32_16x16x32_bf16 v[32:35], v[160:163], v[92:95], v[32:35]
    ds_read_b128 v[80:83], v104 offset:12288
    v_mfma_f32_16x16x32_bf16 v[36:39], v[164:167], v[92:95], v[36:39]
    ds_read_b128 v[84:87], v104 offset:28672
    v_mfma_f32_16x16x32_bf16 v[40:43], v[168:171], v[92:95], v[40:43]
    s_mov_b64 exec, s[70:71]
    ds_read_b128 v[88:91], v106 offset:38912
    s_mov_b64 exec, -1
    v_mfma_f32_16x16x32_bf16 v[44:47], v[172:175], v[92:95], v[44:47]
    v_mfma_f32_16x16x32_bf16 v[48:51], v[160:163], v[96:99], v[48:51]
    v_mfma_f32_16x16x32_bf16 v[52:55], v[164:167], v[96:99], v[52:55]
    v_mfma_f32_16x16x32_bf16 v[56:59], v[168:171], v[96:99], v[56:59]
    v_mfma_f32_16x16x32_bf16 v[60:63], v[172:175], v[96:99], v[60:63]
    v_mfma_f32_16x16x32_bf16 v[64:67], v[160:163], v[100:103], v[64:67]
    v_mfma_f32_16x16x32_bf16 v[68:71], v[164:167], v[100:103], v[68:71]
    v_mfma_f32_16x16x32_bf16 v[72:75], v[168:171], v[100:103], v[72:75]
    v_mfma_f32_16x16x32_bf16 v[76:79], v[172:175], v[100:103], v[76:79]
    s_waitcnt vmcnt(12) lgkmcnt(0)
    v_mfma_f32_16x16x32_bf16 v[32:35], v[176:179], v[80:83], v[32:35]
    ds_read_b128 v[92:95], v105 offset:13312
    v_mfma_f32_16x16x32_bf16 v[36:39], v[180:183], v[80:83], v[36:39]
    ds_read_b128 v[96:99], v105 offset:29696
    v_mfma_f32_16x16x32_bf16 v[40:43], v[184:187], v[80:83], v[40:43]
    s_mov_b64 exec, s[70:71]
    ds_read_b128 v[100:103], v107 offset:39424
    s_mov_b64 exec, -1
    v_mfma_f32_16x16x32_bf16 v[44:47], v[188:191], v[80:83], v[44:47]
    v_mfma_f32_16x16x32_bf16 v[48:51], v[176:179], v[84:87], v[48:51]
    v_mfma_f32_16x16x32_bf16 v[52:55], v[180:183], v[84:87], v[52:55]
    v_mfma_f32_16x16x32_bf16 v[56:59], v[184:187], v[84:87], v[56:59]
    v_mfma_f32_16x16x32_bf16 v[60:63], v[188:191], v[84:87], v[60:63]
    v_mfma_f32_16x16x32_bf16 v[64:67], v[176:179], v[88:91], v[64:67]
    v_mfma_f32_16x16x32_bf16 v[68:71], v[180:183], v[88:91], v[68:71]
    v_mfma_f32_16x16x32_bf16 v[72:75], v[184:187], v[88:91], v[72:75]
    v_mfma_f32_16x16x32_bf16 v[76:79], v[188:191], v[88:91], v[76:79]
    s_waitcnt vmcnt(8) lgkmcnt(0)
    v_mfma_f32_16x16x32_bf16 v[32:35], v[192:195], v[92:95], v[32:35]
    ds_read_b128 v[80:83], v104 offset:14336
    v_mfma_f32_16x16x32_bf16 v[36:39], v[196:199], v[92:95], v[36:39]
    ds_read_b128 v[84:87], v104 offset:30720
    v_mfma_f32_16x16x32_bf16 v[40:43], v[200:203], v[92:95], v[40:43]
    s_mov_b64 exec, s[70:71]
    ds_read_b128 v[88:91], v106 offset:39936
    s_mov_b64 exec, -1
    v_mfma_f32_16x16x32_bf16 v[44:47], v[204:207], v[92:95], v[44:47]
    v_mfma_f32_16x16x32_bf16 v[48:51], v[192:195], v[96:99], v[48:51]
    v_mfma_f32_16x16x32_bf16 v[52:55], v[196:199], v[96:99], v[52:55]
    v_mfma_f32_16x16x32_bf16 v[56:59], v[200:203], v[96:99], v[56:59]
    v_mfma_f32_16x16x32_bf16 v[60:63], v[204:207], v[96:99], v[60:63]
    v_mfma_f32_16x16x32_bf16 v[64:67], v[192:195], v[100:103], v[64:67]
    v_mfma_f32_16x16x32_bf16 v[68:71], v[196:199], v[100:103], v[68:71]
    v_mfma_f32_16x16x32_bf16 v[72:75], v[200:203], v[100:103], v[72:75]
    v_mfma_f32_16x16x32_bf16 v[76:79], v[204:207], v[100:103], v[76:79]
    s_waitcnt vmcnt(4) lgkmcnt(0)
    v_mfma_f32_16x16x32_bf16 v[32:35], v[208:211], v[80:83], v[32:35]
    ds_read_b128 v[92:95], v105 offset:15360
    v_mfma_f32_16x16x32_bf16 v[36:39], v[212:215], v[80:83], v[36:39]
    ds_read_b128 v[96:99], v105 offset:31744
    v_mfma_f32_16x16x32_bf16 v[40:43], v[216:219], v[80:83], v[40:43]
    s_mov_b64 exec, s[70:71]
    ds_read_b128 v[100:103], v107 offset:40448
    s_mov_b64 exec, -1
    v_mfma_f32_16x16x32_bf16 v[44:47], v[220:223], v[80:83], v[44:47]
    v_mfma_f32_16x16x32_bf16 v[48:51], v[208:211], v[84:87], v[48:51]
    v_mfma_f32_16x16x32_bf16 v[52:55], v[212:215], v[84:87], v[52:55]
    v_mfma_f32_16x16x32_bf16 v[56:59], v[216:219], v[84:87], v[56:59]
    v_mfma_f32_16x16x32_bf16 v[60:63], v[220:223], v[84:87], v[60:63]
    v_mfma_f32_16x16x32_bf16 v[64:67], v[208:211], v[88:91], v[64:67]
    v_mfma_f32_16x16x32_bf16 v[68:71], v[212:215], v[88:91], v[68:71]
    v_mfma_f32_16x16x32_bf16 v[72:75], v[216:219], v[88:91], v[72:75]
    v_mfma_f32_16x16x32_bf16 v[76:79], v[220:223], v[88:91], v[76:79]
    s_waitcnt vmcnt(0) lgkmcnt(0)
    v_mfma_f32_16x16x32_bf16 v[32:35], v[224:227], v[92:95], v[32:35]
    v_mfma_f32_16x16x32_bf16 v[36:39], v[228:231], v[92:95], v[36:39]
    v_mfma_f32_16x16x32_bf16 v[40:43], v[232:235], v[92:95], v[40:43]
    v_mfma_f32_16x16x32_bf16 v[44:47], v[236:239], v[92:95], v[44:47]
    v_mfma_f32_16x16x32_bf16 v[48:51], v[224:227], v[96:99], v[48:51]
    v_mfma_f32_16x16x32_bf16 v[52:55], v[228:231], v[96:99], v[52:55]
    v_mfma_f32_16x16x32_bf16 v[56:59], v[232:235], v[96:99], v[56:59]
    v_mfma_f32_16x16x32_bf16 v[60:63], v[236:239], v[96:99], v[60:63]
    v_mfma_f32_16x16x32_bf16 v[64:67], v[224:227], v[100:103], v[64:67]
    v_mfma_f32_16x16x32_bf16 v[68:71], v[228:231], v[100:103], v[68:71]
    v_mfma_f32_16x16x32_bf16 v[72:75], v[232:235], v[100:103], v[72:75]
    v_mfma_f32_16x16x32_bf16 v[76:79], v[236:239], v[100:103], v[76:79]
    s_mul_i32 s65, s42, 12288
    s_add_u32 s65, s65, 49152
    v_add_u32 v27, s65, v23
    s_cmp_eq_u32 s41, 0
    s_cbranch_scc1 L_fin0_42
    s_setprio 0
    v_mov_b32 v28, s28
    v_mov_b32 v29, 1
    s_waitcnt lgkmcnt(0)
    s_mov_b64 exec, 1
    ds_add_u32 v28, v29 offset:12
    s_mov_b64 exec, -1
L_sync_43:
    ds_read_b32 v29, v28 offset:12
    s_waitcnt lgkmcnt(0)
    v_cmp_gt_u32 vcc, 4, v29
    s_cbranch_vccz L_syncd_44
    s_add_u32 s96, s96, 1
    s_cmp_lt_u32 s96, 1600000
    s_cbranch_scc1 L_sync_43
L_syncd_44:
    ds_write_b128 v27, v[32:35] offset:0
    ds_write_b128 v27, v[36:39] offset:1024
    ds_write_b128 v27, v[40:43] offset:2048
    ds_write_b128 v27, v[44:47] offset:3072
    ds_write_b128 v27, v[48:51] offset:4096
    ds_write_b128 v27, v[52:55] offset:5120
    ds_write_b128 v27, v[56:59] offset:6144
    ds_write_b128 v27, v[60:63] offset:7168
    ds_write_b128 v27, v[64:67] offset:8192
    ds_write_b128 v27, v[68:71] offset:9216
    ds_write_b128 v27, v[72:75] offset:10240
    ds_write_b128 v27, v[76:79] offset:11264
    v_mov_b32 v28, s28
    v_mov_b32 v29, 1
    s_waitcnt lgkmcnt(0)
    s_mov_b64 exec, 1
    ds_add_u32 v28, v29 offset:16
    s_mov_b64 exec, -1
    s_branch L_fin
L_fin0_42:
    v_and_b32 v24, 15, v1
    v_lshrrev_b32 v25, 4, v1
    v_and_b32 v26, 1, v25
    v_lshrrev_b32 v30, 1, v25
    v_lshlrev_b32 v26, 5, v26
    v_lshl_add_u32 v26, v30, 4, v26
    v_lshl_add_u32 v26, v24, 9, v26
    s_mul_i32 s65, s2, 20480
    s_lshl_b32 s66, s42, 7
    s_add_u32 s65, s65, s66
    v_cmp_gt_u32 s[70:71], 8, v24
    v_mov_b32 v28, s29
L_sync_45:
    ds_read_b32 v29, v28 offset:16
    s_waitcnt lgkmcnt(0)
    v_cmp_gt_u32 vcc, 4, v29
    s_cbranch_vccz L_syncd_46
    s_add_u32 s96, s96, 1
    s_cmp_lt_u32 s96, 1600000
    s_cbranch_scc1 L_sync_45
L_syncd_46:
    ds_read_b128 v[112:115], v27 offset:0
    ds_read_b128 v[116:119], v27 offset:1024
    ds_read_b128 v[120:123], v27 offset:2048
    ds_read_b128 v[124:127], v27 offset:3072
    ds_read_b128 v[128:131], v27 offset:4096
    ds_read_b128 v[132:135], v27 offset:5120
    ds_read_b128 v[136:139], v27 offset:6144
    ds_read_b128 v[140:143], v27 offset:7168
    ds_read_b128 v[144:147], v27 offset:8192
    ds_read_b128 v[148:151], v27 offset:9216
    ds_read_b128 v[152:155], v27 offset:10240
    ds_read_b128 v[156:159], v27 offset:11264
    v_and_b32 v30, 0x3f, v26
    v_mul_u32_u24 v25, 144, v24
    v_add_u32 v25, v25, v30
    s_mul_i32 s66, s42, 12288
    s_add_u32 s66, s66, 49152
    v_add_u32 v25, s66, v25
    v_lshrrev_b32 v30, 3, v1
    v_and_b32 v28, 7, v1
    v_mul_u32_u24 v29, 144, v30
    v_lshl_add_u32 v29, v28, 4, v29
    v_add_u32 v29, s66, v29
    v_lshlrev_b32 v30, 9, v30
    v_lshl_add_u32 v30, v28, 4, v30
    s_waitcnt lgkmcnt(8)
    s_waitcnt lgkmcnt(0)
    v_pk_add_f32 v[32:33], v[32:33], v[112:113]
    v_pk_add_f32 v[34:35], v[34:35], v[114:115]
    v_pk_add_f32 v[36:37], v[36:37], v[116:117]
    v_pk_add_f32 v[38:39], v[38:39], v[118:119]
    v_pk_add_f32 v[40:41], v[40:41], v[120:121]
    v_pk_add_f32 v[42:43], v[42:43], v[122:123]
    v_pk_add_f32 v[44:45], v[44:45], v[124:125]
    v_pk_add_f32 v[46:47], v[46:47], v[126:127]
    v_cvt_pk_bf16_f32 v112, v32, v33
    v_cvt_pk_bf16_f32 v113, v34, v35
    v_cvt_pk_bf16_f32 v114, v36, v37
    v_cvt_pk_bf16_f32 v115, v38, v39
    v_cvt_pk_bf16_f32 v116, v40, v41
    v_cvt_pk_bf16_f32 v117, v42, v43
    v_cvt_pk_bf16_f32 v118, v44, v45
    v_cvt_pk_bf16_f32 v119, v46, v47
    s_add_u32 s66, s65, 0
    s_nop 0
    v_permlane16_swap_b32 v112, v114
    v_permlane16_swap_b32 v113, v115
    v_permlane16_swap_b32 v116, v118
    v_permlane16_swap_b32 v117, v119
    ds_write_b128 v25, v[112:115] offset:0
    ds_write_b128 v25, v[116:119] offset:64
    v_pk_add_f32 v[48:49], v[48:49], v[128:129]
    v_pk_add_f32 v[50:51], v[50:51], v[130:131]
    v_pk_add_f32 v[52:53], v[52:53], v[132:133]
    v_pk_add_f32 v[54:55], v[54:55], v[134:135]
    v_pk_add_f32 v[56:57], v[56:57], v[136:137]
    v_pk_add_f32 v[58:59], v[58:59], v[138:139]
    v_pk_add_f32 v[60:61], v[60:61], v[140:141]
    v_pk_add_f32 v[62:63], v[62:63], v[142:143]
    v_cvt_pk_bf16_f32 v128, v48, v49
    v_cvt_pk_bf16_f32 v129, v50, v51
    v_cvt_pk_bf16_f32 v130, v52, v53
    v_cvt_pk_bf16_f32 v131, v54, v55
    v_cvt_pk_bf16_f32 v132, v56, v57
    v_cvt_pk_bf16_f32 v133, v58, v59
    v_cvt_pk_bf16_f32 v134, v60, v61
    v_cvt_pk_bf16_f32 v135, v62, v63
    s_add_u32 s66, s65, 8192
    s_nop 0
    v_permlane16_swap_b32 v128, v130
    v_permlane16_swap_b32 v129, v131
    v_permlane16_swap_b32 v132, v134
    v_permlane16_swap_b32 v133, v135
    ds_write_b128 v25, v[128:131] offset:2304
    ds_write_b128 v25, v[132:135] offset:2368
    v_pk_add_f32 v[64:65], v[64:65], v[144:145]
    v_pk_add_f32 v[66:67], v[66:67], v[146:147]
    v_pk_add_f32 v[68:69], v[68:69], v[148:149]
    v_pk_add_f32 v[70:71], v[70:71], v[150:151]
    v_pk_add_f32 v[72:73], v[72:73], v[152:153]
    v_pk_add_f32 v[74:75], v[74:75], v[154:155]
    v_pk_add_f32 v[76:77], v[76:77], v[156:157]
    v_pk_add_f32 v[78:79], v[78:79], v[158:159]
    v_cvt_pk_bf16_f32 v144, v64, v65
    v_cvt_pk_bf16_f32 v145, v66, v67
    v_cvt_pk_bf16_f32 v146, v68, v69
    v_cvt_pk_bf16_f32 v147, v70, v71
    v_cvt_pk_bf16_f32 v148, v72, v73
    v_cvt_pk_bf16_f32 v149, v74, v75
    v_cvt_pk_bf16_f32 v150, v76, v77
    v_cvt_pk_bf16_f32 v151, v78, v79
    s_add_u32 s66, s65, 16384
    s_nop 0
    v_permlane16_swap_b32 v144, v146
    v_permlane16_swap_b32 v145, v147
    v_permlane16_swap_b32 v148, v150
    v_permlane16_swap_b32 v149, v151
    ds_write_b128 v25, v[144:147] offset:4608
    ds_write_b128 v25, v[148:151] offset:4672
    s_waitcnt lgkmcnt(0)
    ds_read_b128 v[32:35], v29 offset:0
    ds_read_b128 v[36:39], v29 offset:1152
    ds_read_b128 v[40:43], v29 offset:2304
    ds_read_b128 v[44:47], v29 offset:3456
    ds_read_b128 v[48:51], v29 offset:4608
    s_add_u32 s66, s65, 0
    s_waitcnt lgkmcnt(4)
    buffer_store_dwordx4 v[32:35], v30, s[36:39], s66 offen sc1
    s_add_u32 s66, s65, 4096
    s_waitcnt lgkmcnt(3)
    buffer_store_dwordx4 v[36:39], v30, s[36:39], s66 offen sc1
    s_add_u32 s66, s65, 8192
    s_waitcnt lgkmcnt(2)
    buffer_store_dwordx4 v[40:43], v30, s[36:39], s66 offen sc1
    s_add_u32 s66, s65, 12288
    s_waitcnt lgkmcnt(1)
    buffer_store_dwordx4 v[44:47], v30, s[36:39], s66 offen sc1
    s_add_u32 s66, s65, 16384
    s_waitcnt lgkmcnt(0)
    buffer_store_dwordx4 v[48:51], v30, s[36:39], s66 offen sc1
L_fin:
    s_mov_b64 exec, -1
    s_branch L_end
L_nretry_7:
    s_add_u32 s96, s96, 1
    s_cmp_gt_u32 s96, 200000
    s_cbranch_scc1 L_nok_8
    buffer_load_dwordx2 v[38:39], off, s[32:35], 0 sc1
    s_waitcnt vmcnt(0)
    v_readfirstlane_b32 s65, v38
    v_readfirstlane_b32 s66, v39
    s_nop 1
    s_and_b32 s65, s65, s66
    s_bitcmp1_b32 s65, 31
    s_cbranch_scc0 L_nretry_7
    s_branch L_nok_8
L_w46_14:
    s_waitcnt vmcnt(9)
    s_branch L_w46e_15
L_u_retry_16:
    s_add_u32 s96, s96, 1
    s_cmp_gt_u32 s96, 200000
    s_cbranch_scc1 L_u_ok_17
    s_sleep 2
    buffer_load_dwordx4 v[84:87], v29, s[12:15], s92 offen sc1
    s_waitcnt vmcnt(0)
    v_xor_b32 v24, s44, v84
    v_xor_b32 v25, s45, v85
    v_xor_b32 v26, s46, v86
    v_or3_b32 v24, v24, v25, v26
    v_xor_b32 v25, s47, v87
    v_or_b32 v24, v24, v25
    v_and_b32 v24, 0xfff, v24
    v_cmp_ne_u32 vcc, 0, v24
    s_cbranch_vccnz L_u_retry_16
    s_branch L_u_ok_17
L_e_retry_18:
    s_add_u32 s96, s96, 1
    s_cmp_gt_u32 s96, 200000
    s_cbranch_scc1 L_e_ok_19
    s_sleep 2
    s_mov_b64 exec, s[70:71]
    buffer_load_dwordx4 v[72:75], v28, s[12:15], s94 offen sc1
    buffer_load_dwordx4 v[76:79], v28, s[12:15], s94 offen offset:32 sc1
    s_waitcnt vmcnt(0)
    v_xor_b32 v24, s44, v72
    v_xor_b32 v25, s45, v73
    v_xor_b32 v26, s46, v74
    v_or3_b32 v24, v24, v25, v26
    v_xor_b32 v25, s47, v75
    v_or_b32 v24, v24, v25
    v_xor_b32 v25, s44, v76
    v_xor_b32 v26, s45, v77
    v_or3_b32 v24, v24, v25, v26
    v_xor_b32 v25, s46, v78
    v_xor_b32 v26, s47, v79
    v_or3_b32 v24, v24, v25, v26
    v_and_b32 v24, 0xfff, v24
    v_cmp_ne_u32 vcc, 0, v24
    s_cbranch_vccnz L_e_retry_18
    s_branch L_e_ok_19
L_rare_20:
    v_cmpx_gt_u32 vcc, s92, v76
    v_lshrrev_b32 v24, 12, v76
    v_and_or_b32 v24, v24, 60, s93
    ds_add_rtn_u32 v80, v24, v30
    v_cmpx_gt_u32 vcc, s92, v77
    v_lshrrev_b32 v24, 12, v77
    v_and_or_b32 v24, v24, 60, s93
    ds_add_rtn_u32 v81, v24, v30
    v_cmpx_gt_u32 vcc, s92, v78
    v_lshrrev_b32 v24, 12, v78
    v_and_or_b32 v24, v24, 60, s93
    ds_add_rtn_u32 v82, v24, v30
    v_cmpx_gt_u32 vcc, s92, v79
    v_lshrrev_b32 v24, 12, v79
    v_and_or_b32 v24, v24, 60, s93
    ds_add_rtn_u32 v83, v24, v30
    s_mov_b64 exec, s[70:71]
    s_waitcnt lgkmcnt(0)
    v_cmpx_gt_u32 vcc, s92, v76
    v_lshrrev_b32 v24, 5, v76
    v_and_or_b32 v24, v24, s99, v7
    v_lshl_add_u32 v24, v80, 2, v24
    v_lshrrev_b32 v25, 9, v76
    ds_write_b32 v24, v25
    v_cmpx_gt_u32 vcc, s92, v77
    v_lshrrev_b32 v24, 5, v77
    v_and_or_b32 v24, v24, s99, v7
    v_lshl_add_u32 v24, v81, 2, v24
    v_lshrrev_b32 v25, 9, v77
    ds_write_b32 v24, v25
    v_cmpx_gt_u32 vcc, s92, v78
    v_lshrrev_b32 v24, 5, v78
    v_and_or_b32 v24, v24, s99, v7
    v_lshl_add_u32 v24, v82, 2, v24
    v_lshrrev_b32 v25, 9, v78
    ds_write_b32 v24, v25
    v_cmpx_gt_u32 vcc, s92, v79
    v_lshrrev_b32 v24, 5, v79
    v_and_or_b32 v24, v24, s99, v7
    v_lshl_add_u32 v24, v83, 2, v24
    v_lshrrev_b32 v25, 9, v79
    ds_write_b32 v24, v25
    s_mov_b64 exec, s[70:71]
    v_lshrrev_b32 v24, 12, v79
    v_cmpx_eq_u32 vcc, 0xffffe, v24
    v_mov_b32 v24, 140360
    ds_write_b32 v24, v30
    s_mov_b64 exec, s[70:71]
    s_branch L_rareb_21
L_s_retry_23:
    s_add_u32 s96, s96, 1
    s_cmp_gt_u32 s96, 200000
    s_cbranch_scc1 L_s_ok_24
    s_sleep 2
    s_mov_b32 s92, 4259840
    v_cmpx_gt_u32 vcc, v34, v104
    buffer_load_dwordx4 v[40:43], v36, s[12:15], s92 offen sc1
    s_mov_b64 exec, -1
    v_cmpx_gt_u32 vcc, v35, v108
    buffer_load_dwordx4 v[44:47], v37, s[12:15], s92 offen sc1
    s_mov_b64 exec, -1
    s_waitcnt vmcnt(0)
    v_mov_b32 v29, 0
    v_cmpx_gt_u32 vcc, v34, v104
    v_xor_b32 v25, s44, v40
    v_xor_b32 v26, s45, v41
    v_or3_b32 v29, v29, v25, v26
    v_xor_b32 v25, s46, v42
    v_xor_b32 v26, s47, v43
    v_or3_b32 v29, v29, v25, v26
    s_mov_b64 exec, -1
    v_cmpx_gt_u32 vcc, v35, v108
    v_xor_b32 v25, s44, v44
    v_xor_b32 v26, s45, v45
    v_or3_b32 v29, v29, v25, v26
    v_xor_b32 v25, s46, v46
    v_xor_b32 v26, s47, v47
    v_or3_b32 v29, v29, v25, v26
    s_mov_b64 exec, -1
    v_and_b32 v29, 0xfff, v29
    v_cmp_ne_u32 vcc, 0, v29
    s_cbranch_vccnz L_s_retry_23
    s_branch L_s_ok_24
L_rareC_25:
    s_cmp_gt_u32 s40, 4
    s_cbranch_scc1 L_rareCb_26
    v_cmp_gt_u32 vcc, 32, v1
    s_mov_b64 s[70:71], vcc
    s_lshl_b32 s98, s40, 1
    s_add_u32 s99, s98, 1
    s_mov_b32 s100, 96
    s_mov_b32 s101, 31
    v_mov_b32 v26, s99
    v_mov_b32 v27, s98
    v_cndmask_b32 v26, v26, v27, s[70:71]
    v_and_b32 v104, s101, v1
    v_add_u32 v104, s100, v104
    v_lshlrev_b32 v105, 2, v26
    v_add_u32 v105, 140288, v105
    v_lshl_add_u32 v28, v26, 9, v7
    v_lshl_add_u32 v106, v104, 2, v28
    v_lshlrev_b32 v28, 12, v26
    v_lshrrev_b32 v27, 5, v104
    v_lshl_add_u32 v28, v27, 10, v28
    v_and_b32 v27, 3, v104
    v_lshl_add_u32 v28, v27, 8, v28
    v_bfe_u32 v27, v104, 2, 3
    v_lshl_add_u32 v28, v27, 1, v28
    v_add_u32 v107, 98304, v28
    ds_read_b32 v34, v105
    ds_read_b32 v32, v106
    s_mov_b32 s92, 4259840
    s_movk_i32 s99, 0x3f0
    v_mov_b32 v29, 139264
    s_waitcnt lgkmcnt(0)
    v_cmpx_gt_u32 vcc, v34, v104
    v_lshrrev_b32 v24, 5, v32
    v_and_b32 v36, 0x3fff0, v24
    v_lshlrev_b32 v24, 1, v32
    v_and_or_b32 v38, v24, s99, v29
    buffer_load_dwordx4 v[40:43], v36, s[12:15], s92 offen sc1
    ds_read_b128 v[48:51], v38
    s_mov_b64 exec, -1
    s_waitcnt vmcnt(0) lgkmcnt(0)
L_cpoll_47:
    v_mov_b32 v29, 0
    v_cmpx_gt_u32 vcc, v34, v104
    v_xor_b32 v25, s44, v40
    v_xor_b32 v26, s45, v41
    v_or3_b32 v29, v29, v25, v26
    v_xor_b32 v25, s46, v42
    v_xor_b32 v26, s47, v43
    v_or3_b32 v29, v29, v25, v26
    s_mov_b64 exec, -1
    v_and_b32 v29, 0xfff, v29
    v_cmp_ne_u32 vcc, 0, v29
    s_cbranch_vccz L_cdone_48
    s_add_u32 s96, s96, 1
    s_cmp_gt_u32 s96, 200000
    s_cbranch_scc1 L_cdone_48
    v_cmpx_gt_u32 vcc, v34, v104
    buffer_load_dwordx4 v[40:43], v36, s[12:15], s92 offen sc1
    s_mov_b64 exec, -1
    s_waitcnt vmcnt(0)
    s_branch L_cpoll_47
L_cdone_48:
    s_mov_b32 s92, 0xfffff000
    v_cmpx_gt_u32 vcc, v34, v104
    v_and_b32 v40, s92, v40
    v_and_b32 v41, s92, v41
    v_and_b32 v42, s92, v42
    v_and_b32 v43, s92, v43
    v_pk_add_f32 v[40:41], v[40:41], v[48:49]
    v_pk_add_f32 v[42:43], v[42:43], v[50:51]
    v_mul_f32 v48, 0x3e4ccccd, v40
    v_mul_f32 v49, 0x3e4ccccd, v41
    v_mul_f32 v50, 0x3e4ccccd, v42
    v_mul_f32 v51, 0x3e4ccccd, v43
    v_max_f32 v40, v40, v48
    v_max_f32 v41, v41, v49
    v_max_f32 v42, v42, v50
    v_max_f32 v43, v43, v51
    v_exp_f32 v40, v40
    v_exp_f32 v41, v41
    v_exp_f32 v42, v42
    v_exp_f32 v43, v43
    v_bfe_u32 v24, v32, 3, 2
    v_lshl_add_u32 v24, v24, 6, v107
    v_cvt_pk_bf16_f32 v48, v40, v41
    v_cvt_pk_bf16_f32 v49, v42, v43
    ds_write_b16 v24, v48
    ds_write_b16_d16_hi v24, v48 offset:16
    ds_write_b16 v24, v49 offset:32
    ds_write_b16_d16_hi v24, v49 offset:48
    s_mov_b64 exec, -1
    s_branch L_rareCb_26
L_hot_end:
L_slow:
    s_waitcnt vmcnt(0) lgkmcnt(0)
    s_mov_b64 exec, -1
    v_mov_b32 v128, 0
    v_mov_b32 v129, 0
    v_mov_b32 v130, 0
    v_mov_b32 v131, 0
    v_mov_b32 v132, 0x40000000
    v_mov_b32 v133, 0x40000000
    v_mov_b32 v134, 0x40000000
    v_mov_b32 v135, 0x40000000
    s_barrier
    s_mov_b32 s31, 0
L_sl_g_49:
    v_mov_b64 v[32:33], 0
    v_mov_b64 v[34:35], 0
    v_mov_b64 v[36:37], 0
    v_mov_b64 v[38:39], 0
    v_mov_b64 v[40:41], 0
    v_mov_b64 v[42:43], 0
    v_mov_b64 v[44:45], 0
    v_mov_b64 v[46:47], 0
    v_mov_b64 v[48:49], 0
    v_mov_b64 v[50:51], 0
    v_lshlrev_b32 v124, 4, v0
    v_add_u32 v125, 98304, v124
    v_cmpx_gt_u32 vcc, 0x100, v0
    ds_write_b128 v125, v[128:131]
    v_add_u32 v125, 147456, v124
    v_cmpx_gt_u32 vcc, 32, v0
    ds_write_b128 v125, v[132:135]
    v_mov_b32 v125, 140364
    ds_write_b32 v125, v128
    s_mov_b64 exec, -1
    s_waitcnt lgkmcnt(0)
    s_barrier
    s_mov_b32 s30, 0
L_sl_c_50:
    v_lshlrev_b32 v124, 2, v0
    s_lshl_b32 s65, s30, 9
    v_cmpx_gt_u32 vcc, 0x80, v0
    buffer_load_dword v112, v124, s[20:23], s65 offen
    buffer_load_dword v113, v124, s[16:19], s65 offen
    s_mul_i32 s66, s2, 40
    s_lshl_b32 s67, s31, 2
    s_add_u32 s67, s67, s66
    s_waitcnt vmcnt(0)
    v_subrev_u32 v125, s67, v112
    v_subrev_u32 v126, s66, v112
    v_cmpx_gt_u32 vcc, 4, v125
    v_mov_b32 v124, 140364
    v_mov_b32 v125, 1
    ds_add_rtn_u32 v127, v124, v125
    v_lshlrev_b32 v114, 9, v113
    v_lshl_or_b32 v114, v126, 3, v114
    s_waitcnt lgkmcnt(0)
    v_lshl_add_u32 v127, v127, 2, v7
    ds_write_b32 v127, v114
    s_mov_b64 exec, -1
    s_waitcnt lgkmcnt(0)
    s_barrier
    v_mov_b32 v124, 140364
    ds_read_b32 v115, v124
    s_waitcnt lgkmcnt(0)
    v_readfirstlane_b32 s62, v115
    s_barrier
    s_cmp_eq_u32 s62, 0
    s_cbranch_scc1 L_sl_next_51
    v_cmpx_gt_u32 vcc, s62, v0
    s_cbranch_execz L_sl_noe_53
    v_lshl_add_u32 v124, v0, 2, v7
    ds_read_b32 v114, v124
    s_waitcnt lgkmcnt(0)
    v_lshrrev_b32 v124, 5, v114
    v_and_b32 v112, 0x3fff0, v124
    v_lshlrev_b32 v124, 1, v114
    v_and_b32 v124, 0x3f0, v124
    v_add_u32 v124, 139264, v124
    ds_read_b128 v[120:123], v124
    s_mov_b32 s65, 4259840
L_sl_poll_54:
    buffer_load_dwordx4 v[116:119], v112, s[12:15], s65 offen sc1
    s_waitcnt vmcnt(0) lgkmcnt(0)
    v_xor_b32 v124, s44, v116
    v_xor_b32 v125, s45, v117
    v_xor_b32 v126, s46, v118
    v_or3_b32 v124, v124, v125, v126
    v_xor_b32 v125, s47, v119
    v_or_b32 v124, v124, v125
    v_and_b32 v124, 0xfff, v124
    v_cmp_ne_u32 vcc, 0, v124
    s_cbranch_vccz L_sl_ok_55
    s_add_u32 s96, s96, 1
    s_cmp_lt_u32 s96, 3200000
    s_cbranch_scc1 L_sl_poll_54
L_sl_ok_55:
    s_mov_b32 s65, 0xfffff000
    v_and_b32 v116, s65, v116
    v_and_b32 v117, s65, v117
    v_and_b32 v118, s65, v118
    v_and_b32 v119, s65, v119
    v_add_f32 v116, v116, v120
    v_add_f32 v117, v117, v121
    v_add_f32 v118, v118, v122
    v_add_f32 v119, v119, v123
    v_mul_f32 v120, 0x3e4ccccd, v116
    v_mul_f32 v121, 0x3e4ccccd, v117
    v_mul_f32 v122, 0x3e4ccccd, v118
    v_mul_f32 v123, 0x3e4ccccd, v119
    v_max_f32 v116, v116, v120
    v_max_f32 v117, v117, v121
    v_max_f32 v118, v118, v122
    v_max_f32 v119, v119, v123
    v_exp_f32 v116, v116
    v_exp_f32 v117, v117
    v_exp_f32 v118, v118
    v_exp_f32 v119, v119
    v_lshrrev_b32 v124, 5, v0
    v_lshlrev_b32 v124, 10, v124
    v_and_b32 v125, 3, v0
    v_lshl_add_u32 v124, v125, 8, v124
    v_bfe_u32 v125, v0, 2, 3
    v_lshl_add_u32 v124, v125, 1, v124
    v_bfe_u32 v125, v114, 3, 2
    v_lshl_add_u32 v124, v125, 6, v124
    v_add_u32 v124, 98304, v124
    v_cvt_pk_bf16_f32 v120, v116, v117
    v_cvt_pk_bf16_f32 v121, v118, v119
    ds_write_b16 v124, v120
    ds_write_b16_d16_hi v124, v120 offset:16
    ds_write_b16 v124, v121 offset:32
    ds_write_b16_d16_hi v124, v121 offset:48
L_sl_noe_53:
    s_mov_b64 exec, -1
    s_waitcnt lgkmcnt(0)
    s_barrier
    s_cmp_ge_u32 s31, 5
    s_cselect_b32 s65, 1, 0
    s_cmp_lg_u32 s65, s43
    s_cbranch_scc1 L_sl_nom_56
    v_mov_b32 v24, 0x3f803f80
    v_mov_b32 v25, 0x3f803f80
    v_mov_b32 v26, 0x3f803f80
    v_mov_b32 v27, 0x3f803f80
    s_mov_b32 s63, 0
L_sl_step_57:
    s_lshl_b32 s65, s63, 7
    v_add_u32 v124, s65, v8
    s_lshl_b32 s65, s63, 10
    v_add_u32 v125, s65, v6
    ds_read_b128 v[12:15], v124
    ds_read_b128 v[16:19], v125
    s_mov_b32 m0, s56
    s_waitcnt lgkmcnt(0)
    v_and_or_b32 v12, v12, s97, v9
    v_and_or_b32 v13, v13, s97, v10
    v_and_or_b32 v14, v14, s97, v9
    v_and_or_b32 v15, v15, s97, v10
    buffer_load_dwordx4 v12, s[4:7], s52 offen offset:0 lds
    buffer_load_dwordx4 v13, s[4:7], s53 offen offset:1024 lds
    buffer_load_dwordx4 v14, s[4:7], s54 offen offset:2048 lds
    buffer_load_dwordx4 v15, s[4:7], s55 offen offset:3072 lds
    s_waitcnt vmcnt(0)
    ds_read_b64_tr_b16 v[240:241], v2
    ds_read_b64_tr_b16 v[242:243], v2 offset:512
    ds_read_b64_tr_b16 v[244:245], v3
    ds_read_b64_tr_b16 v[246:247], v3 offset:512
    ds_read_b64_tr_b16 v[248:249], v4
    ds_read_b64_tr_b16 v[250:251], v4 offset:512
    ds_read_b64_tr_b16 v[252:253], v5
    ds_read_b64_tr_b16 v[254:255], v5 offset:512
    s_waitcnt lgkmcnt(0)
    v_mfma_f32_16x16x32_bf16 v[48:51], v[16:19], v[24:27], v[48:51]
    v_mfma_f32_16x16x32_bf16 v[32:35], v[16:19], v[240:243], v[32:35]
    v_mfma_f32_16x16x32_bf16 v[36:39], v[16:19], v[244:247], v[36:39]
    v_mfma_f32_16x16x32_bf16 v[40:43], v[16:19], v[248:251], v[40:43]
    v_mfma_f32_16x16x32_bf16 v[44:47], v[16:19], v[252:255], v[44:47]
    s_add_u32 s63, s63, 1
    s_lshl_b32 s65, s63, 5
    s_cmp_lt_u32 s65, s62
    s_cbranch_scc1 L_sl_step_57
L_sl_nom_56:
    s_barrier
    v_lshlrev_b32 v124, 4, v0
    v_add_u32 v125, 98304, v124
    v_cmpx_gt_u32 vcc, 0x100, v0
    ds_write_b128 v125, v[128:131]
    v_add_u32 v125, 147456, v124
    v_cmpx_gt_u32 vcc, 32, v0
    ds_write_b128 v125, v[132:135]
    v_mov_b32 v125, 140364
    ds_write_b32 v125, v128
    s_mov_b64 exec, -1
    s_waitcnt lgkmcnt(0)
    s_barrier
L_sl_next_51:
    s_add_u32 s30, s30, 1
    s_cmp_lt_u32 s30, 1250
    s_cbranch_scc1 L_sl_c_50
    s_cmp_ge_u32 s31, 5
    s_cselect_b32 s65, 1, 0
    s_cmp_lg_u32 s65, s43
    s_cbranch_scc1 L_sl_ge_52
    s_mul_i32 s66, s43, 5
    s_sub_u32 s65, s31, s66
    s_lshl_b32 s65, s65, 3
    s_nop 7
    v_fmaak_f32 v48, 4.0, v48, 0x3189705f
    v_fmaak_f32 v49, 4.0, v49, 0x3189705f
    v_fmaak_f32 v50, 4.0, v50, 0x3189705f
    v_fmaak_f32 v51, 4.0, v51, 0x3189705f
    v_rcp_f32 v48, v48
    v_rcp_f32 v49, v49
    v_rcp_f32 v50, v50
    v_rcp_f32 v51, v51
    s_nop 0
    v_pk_mul_f32 v[32:33], v[32:33], v[48:49]
    v_pk_mul_f32 v[34:35], v[34:35], v[50:51]
    v_pk_mul_f32 v[36:37], v[36:37], v[48:49]
    v_pk_mul_f32 v[38:39], v[38:39], v[50:51]
    v_pk_mul_f32 v[40:41], v[40:41], v[48:49]
    v_pk_mul_f32 v[42:43], v[42:43], v[50:51]
    v_pk_mul_f32 v[44:45], v[44:45], v[48:49]
    v_pk_mul_f32 v[46:47], v[46:47], v[50:51]
    s_set_gpr_idx_on s65, gpr_idx(DST)
    s_nop 0
    v_cvt_pk_bf16_f32 v52, v32, v33
    v_cvt_pk_bf16_f32 v53, v34, v35
    v_cvt_pk_bf16_f32 v54, v36, v37
    v_cvt_pk_bf16_f32 v55, v38, v39
    v_cvt_pk_bf16_f32 v56, v40, v41
    v_cvt_pk_bf16_f32 v57, v42, v43
    v_cvt_pk_bf16_f32 v58, v44, v45
    v_cvt_pk_bf16_f32 v59, v46, v47
    s_set_gpr_idx_off
    v_mov_b64 v[32:33], 0
    v_mov_b64 v[34:35], 0
    v_mov_b64 v[36:37], 0
    v_mov_b64 v[38:39], 0
    v_mov_b64 v[40:41], 0
    v_mov_b64 v[42:43], 0
    v_mov_b64 v[44:45], 0
    v_mov_b64 v[46:47], 0
    v_mov_b64 v[48:49], 0
    v_mov_b64 v[50:51], 0
L_sl_ge_52:
    s_add_u32 s31, s31, 1
    s_cmp_lt_u32 s31, 10
    s_cbranch_scc1 L_sl_g_49
    s_add_u32 s66, s3, 0
    buffer_load_dwordx4 v[112:115], v23, s[12:15], s66 offen offset:0 sc1
    buffer_load_dwordx4 v[116:119], v23, s[12:15], s66 offen offset:1024 sc1
    buffer_load_dwordx4 v[120:123], v23, s[12:15], s66 offen offset:2048 sc1
    buffer_load_dwordx4 v[124:127], v23, s[12:15], s66 offen offset:3072 sc1
    s_add_u32 s66, s3, 4096
    buffer_load_dwordx4 v[128:131], v23, s[12:15], s66 offen offset:0 sc1
    buffer_load_dwordx4 v[132:135], v23, s[12:15], s66 offen offset:1024 sc1
    buffer_load_dwordx4 v[136:139], v23, s[12:15], s66 offen offset:2048 sc1
    buffer_load_dwordx4 v[140:143], v23, s[12:15], s66 offen offset:3072 sc1
    v_and_b32 v26, 15, v1
    v_lshrrev_b32 v92, 4, v1
    v_bfe_u32 v27, v26, 1, 2
    v_lshrrev_b32 v28, 3, v26
    v_lshl_add_u32 v93, v28, 2, v27
    v_and_b32 v30, 1, v26
    v_lshlrev_b32 v30, 3, v30
    s_mul_i32 s65, s41, 49152
    s_and_b32 s66, s48, 1
    s_lshl_b32 s67, s66, 13
    s_add_u32 s67, s67, s65
    s_lshl_b32 s66, s66, 12
    s_add_u32 s66, s66, s65
    v_lshl_add_u32 v94, v27, 8, v30
    v_lshl_add_u32 v94, v28, 10, v94
    v_add_u32 v94, s67, v94
    v_lshl_add_u32 v95, v27, 7, v30
    v_lshl_add_u32 v95, v28, 9, v95
    v_add_u32 v95, s66, v95
    v_lshrrev_b32 v25, 4, v1
    v_add_u32 v100, 0, v25
    v_xor_b32 v27, v26, v100
    v_lshlrev_b32 v27, 4, v27
    v_lshl_add_u32 v27, v25, 8, v27
    v_add_u32 v104, s65, v27
    v_and_b32 v27, 7, v26
    v_xor_b32 v27, v27, v100
    v_lshlrev_b32 v27, 4, v27
    v_lshl_add_u32 v27, v25, 7, v27
    v_add_u32 v106, s65, v27
    v_add_u32 v100, 4, v25
    v_xor_b32 v27, v26, v100
    v_lshlrev_b32 v27, 4, v27
    v_lshl_add_u32 v27, v25, 8, v27
    v_add_u32 v105, s65, v27
    v_and_b32 v27, 7, v26
    v_xor_b32 v27, v27, v100
    v_lshlrev_b32 v27, 4, v27
    v_lshl_add_u32 v27, v25, 7, v27
    v_add_u32 v107, s65, v27
    s_waitcnt vmcnt(0)
    s_branch L_aggw
L_end:
    s_waitcnt vmcnt(0)
    s_endpgm
.section .rodata,"a"
.p2align 6
.amdhsa_kernel gather_scatter__graph_attention_gat__graph_kernel
.amdhsa_next_free_vgpr 256
.amdhsa_next_free_sgpr 102
.amdhsa_accum_offset 256
.amdhsa_group_segment_fixed_size 0
.amdhsa_kernarg_size 72
.amdhsa_user_sgpr_count 2
.amdhsa_user_sgpr_kernarg_segment_ptr 1
.amdhsa_system_sgpr_workgroup_id_x 1
.amdhsa_float_denorm_mode_32 3
.amdhsa_float_denorm_mode_16_64 3
.end_amdhsa_kernel
```
